```python
import torch

def _softmax(x, axis=-1):
    return torch.softmax(x, dim=axis)
def _gelu(x):
    return torch.nn.functional.gelu(x, approximate="tanh")
def _silu(x):
    return torch.nn.functional.silu(x)
def _sigmoid(x):
    return torch.sigmoid(x)
def _layernorm(x, axis=-1, eps=1e-5):
    m = x.mean(dim=axis, keepdim=True)
    v = x.var(dim=axis, keepdim=True, unbiased=False)
    return (x - m) / torch.sqrt(v + eps)
def _scatter_add(tgt, idx, src, axis=0):
    return tgt.clone().index_add_(axis, idx, src)
def _segment_sum(src, seg, n):
    out = torch.zeros((n,) + src.shape[1:], dtype=src.dtype)
    return out.index_add_(0, seg, src)
def _pad(x, pw):
    flat = tuple(v for pair in reversed(pw) for v in pair)
    return torch.nn.functional.pad(x, flat)

kernel_name = 'concat_heads__ssm_conv_s4__grouped_kv_mqa__prompt'

def setup_inputs():

    _w = (lambda a: (lambda t: t.to(torch.bfloat16) if t.is_floating_point() else t)(torch.as_tensor(a)))
    def _A_setup():
        B, L, D, N = 1, 2048, 640, 128
        A_re = -(lambda _x: torch.exp(torch.as_tensor(_x)))((lambda *s: torch.randn(*s, dtype=torch.bfloat16) * 6.4)(D, N))
        A_im = torch.pi * (lambda *s: torch.randn(*s, dtype=torch.bfloat16) * 0.1)(D, N)
        B_re = (lambda *s: torch.randn(*s, dtype=torch.bfloat16) * 0.1)(D, N)
        B_im = (lambda *s: torch.randn(*s, dtype=torch.bfloat16) * 0.1)(D, N)
        C_re = (lambda *s: torch.randn(*s, dtype=torch.bfloat16) * 0.1)(D, N)
        C_im = (lambda *s: torch.randn(*s, dtype=torch.bfloat16) * 0.1)(D, N)
        log_dt = (lambda *s: torch.randn(*s, dtype=torch.bfloat16) * 0.1)(D) * 0.5 - 4.0
        Dskip = (lambda *s: torch.randn(*s, dtype=torch.bfloat16) * 0.1)(D)
        return {
            "u": _w((lambda *s: torch.randn(*s, dtype=torch.bfloat16) * 0.05)(B, L, D)),
            "A_re": _w(A_re),
            "A_im": _w(A_im),
            "B_re": _w(B_re),
            "B_im": _w(B_im),
            "C_re": _w(C_re),
            "C_im": _w(C_im),
            "log_dt": _w(log_dt),
            "Dskip": _w(Dskip),
        }
    _A_in = _A_setup()

    def _B_setup():
        B, S, D, H = 1, 2048, 640, 32
        Dh = D // H
        return {
            "x": _w((lambda *s: torch.randn(*s, dtype=torch.bfloat16) * 0.05)(B, S, D)),
            "wq": _w((lambda *s: torch.randn(*s, dtype=torch.bfloat16) * 0.8)(D, H * Dh)),
            "wk": _w((lambda *s: torch.randn(*s, dtype=torch.bfloat16) * 0.8)(D, Dh)),
            "wv": _w((lambda *s: torch.randn(*s, dtype=torch.bfloat16) * 0.05)(D, Dh)),
            "wo": _w((lambda *s: torch.randn(*s, dtype=torch.bfloat16) * 0.05)(H * Dh, D)),
        }
    _B_in = _B_setup()

    return {
        "A_u": _A_in["u"],
        "A_A_re": _A_in["A_re"],
        "A_A_im": _A_in["A_im"],
        "A_B_re": _A_in["B_re"],
        "A_B_im": _A_in["B_im"],
        "A_C_re": _A_in["C_re"],
        "A_C_im": _A_in["C_im"],
        "A_log_dt": _A_in["log_dt"],
        "A_Dskip": _A_in["Dskip"],
        "B_x": _B_in["x"],
        "B_wq": _B_in["wq"],
        "B_wk": _B_in["wk"],
        "B_wv": _B_in["wv"],
        "B_wo": _B_in["wo"],
    }

def reference(A_u, A_A_re, A_A_im, A_B_re, A_B_im, A_C_re, A_C_im, A_log_dt, A_Dskip, B_x, B_wq, B_wk, B_wv, B_wo):
    def _A_ref(u, A_re, A_im, B_re, B_im, C_re, C_im, log_dt, Dskip):
        Bsz, L, D = u.shape
        dt = torch.exp(log_dt)[:, None]
        A = A_re + 1j * A_im
        Bc = B_re + 1j * B_im
        Cc = C_re + 1j * C_im
        logdA = dt * A
        dB = dt * Bc
        l = (lambda x, dt: x.to(dt))(torch.arange(L), A_re.dtype)
        P = torch.exp(logdA[:, :, None] * l[None, None, :])
        K = torch.einsum("dn,dnl,dn->dl", Cc, P, dB).real
        L2 = 2 * L
        Kp = _pad(K, ((0, 0), (0, L)))
        up = (lambda x, *d: x.permute(*d))(u, 0, 2, 1)
        up = _pad(up, ((0, 0), (0, 0), (0, L)))
        Kf = (lambda x, axes=(-2,-1): torch.fft.rfft2(x.float(), dim=axes))(Kp[:, None, :], axes=(-2, -1))
        Uf = (lambda x, axes=(-2,-1): torch.fft.rfft2(x.float(), dim=axes))(up[:, :, None, :], axes=(-2, -1))
        Yf = Uf * Kf[None, :, :, :]
        y = (lambda x, s, axes=(-2,-1): torch.fft.irfft2(x, s=s, dim=axes).to(torch.bfloat16))(Yf, (1, L2), axes=(-2, -1))[:, :, 0, :L]
        y = (lambda x, *d: x.permute(*d))(y, 0, 2, 1) + u * Dskip[None, None, :]
        return y

    def _B_ref(x, wq, wk, wv, wo):
        B, S, D = x.shape
        H = 32
        Dh = D // H
        q = (lambda x, *d: x.permute(*d))((x @ wq).reshape(B, S, H, Dh), 0, 2, 1, 3)
        k = x @ wk
        v = x @ wv
        scores = torch.einsum("bhqd,bkd->bhqk", q, k) * (Dh ** -0.5)
        p = _softmax(scores, axis=-1)
        o = torch.einsum("bhqk,bkd->bhqd", p, v)
        return (lambda x, *d: x.permute(*d))(o, 0, 2, 1, 3).reshape(B, S, H * Dh) @ wo

    a = _A_ref(A_u, A_A_re, A_A_im, A_B_re, A_B_im, A_C_re, A_C_im, A_log_dt, A_Dskip)
    b = _B_ref(B_x, B_wq, B_wk, B_wv, B_wo)
    return torch.concatenate([a, b], axis=-1)
```

```asm
; @launch grid=(512,1,1) block=(512,1,1) lds=81920
.amdgcn_target "amdgcn-amd-amdhsa--gfx950"
.text
.globl concat_heads__ssm_conv_s4__grouped_kv_mqa__prompt_kernel
.p2align 8
.type concat_heads__ssm_conv_s4__grouped_kv_mqa__prompt_kernel,@function
concat_heads__ssm_conv_s4__grouped_kv_mqa__prompt_kernel:
  s_cmp_ge_u32 s2, 512
  s_cbranch_scc1 L_exit
  s_cmp_ge_u32 s2, 256
  s_cbranch_scc1 L_roleB
  s_setprio 2
  s_and_b32 s3, s2, 255
  s_load_dwordx2 s[8:9], s[0:1], 72
  s_load_dwordx2 s[12:13], s[0:1], 80
  s_load_dwordx2 s[16:17], s[0:1], 128
  s_load_dwordx2 s[20:21], s[0:1], 120
  s_load_dwordx2 s[48:49], s[0:1], 0
  s_load_dwordx2 s[52:53], s[0:1], 112
  s_load_dwordx2 s[46:47], s[0:1], 64
  v_lshrrev_b32 v1, 6, v0
  s_and_b32 s4, s3, 7
  s_lshr_b32 s5, s3, 3
  v_readfirstlane_b32 s6, v1
  v_and_b32 v0, 63, v0
  s_lshr_b32 s7, s5, 3
  s_lshl_b32 s7, s7, 3
  s_add_u32 s24, s7, s4
  s_and_b32 s25, s5, 7
  s_lshr_b32 s7, s25, 1
  s_and_b32 s7, s7, 1
  s_lshl_b32 s7, s7, 3
  s_add_u32 s7, s7, 88
  s_load_dwordx2 s[92:93], s[0:1], s7
  s_and_b32 s26, s6, 3
  s_lshr_b32 s27, s6, 2
  s_mov_b32 s10, 2621440
  s_mov_b32 s11, 0x20000
  s_mov_b32 s14, 819200
  s_mov_b32 s15, 0x20000
  s_mov_b32 s18, 8683520
  s_mov_b32 s19, 0x20000
  s_mov_b32 s22, 256
  s_mov_b32 s23, 0x20000
  s_mov_b32 s50, 2621440
  s_mov_b32 s51, 0x20000
  s_mov_b32 s54, 5242880
  s_mov_b32 s55, 0x20000
  s_mov_b32 s94, 25600
  s_mov_b32 s95, 0x20000
  v_lshrrev_b32 v20, 3, v0
  v_mul_u32_u24 v23, 1280, v20
  v_lshrrev_b32 v21, 4, v0
  s_and_b32 s7, s6, 1
  s_lshl_b32 s7, s7, 2
  v_add_u32 v21, s7, v21
  v_xor_b32 v21, v21, v0
  v_and_b32 v21, 7, v21
  v_lshl_add_u32 v21, v21, 4, v23
  s_lshl_b32 s32, s24, 3
  s_add_u32 s32, s32, s6
  s_mul_i32 s32, s32, 10240
  v_add_u32 v2, s32, v21
  s_mul_i32 s32, s6, 10240
  s_mul_i32 s33, s25, 160
  s_add_u32 s32, s32, s33
  v_mov_b32 v20, v0
  v_mul_u32_u24 v21, 6554, v20
  v_lshrrev_b32 v21, 16, v21
  v_mul_u32_u24 v21, 1120, v21
  v_lshl_add_u32 v21, v20, 4, v21
  v_add_u32 v4, s32, v21
  v_add_u32 v20, 64, v0
  v_mul_u32_u24 v21, 6554, v20
  v_lshrrev_b32 v21, 16, v21
  v_mul_u32_u24 v21, 1120, v21
  v_lshl_add_u32 v21, v20, 4, v21
  v_add_u32 v5, s32, v21
  v_lshlrev_b32 v6, 4, v0
  s_lshl_b32 s28, s6, 10
  s_mul_i32 s29, s6, 1280
  s_add_u32 s29, s29, 8192
  s_waitcnt lgkmcnt(0)
  s_mov_b32 s30, 0
  s_mov_b32 s31, 0
  s_add_u32 m0, s28, 0
  s_nop 0
  buffer_load_dwordx4 v2, s[8:11], s30 offen lds
  s_add_u32 m0, s29, 0
  s_nop 0
  buffer_load_dwordx4 v4, s[12:15], s31 offen lds
  s_add_u32 m0, s29, 1024
  s_mov_b64 exec, 0xffff
  buffer_load_dwordx4 v5, s[12:15], s31 offen lds
  s_mov_b64 exec, -1
  s_mov_b32 s30, 128
  s_mov_b32 s31, 81920
  s_add_u32 m0, s28, 18432
  s_nop 0
  buffer_load_dwordx4 v2, s[8:11], s30 offen lds
  s_add_u32 m0, s29, 18432
  s_nop 0
  buffer_load_dwordx4 v4, s[12:15], s31 offen lds
  s_add_u32 m0, s29, 19456
  s_mov_b64 exec, 0xffff
  buffer_load_dwordx4 v5, s[12:15], s31 offen lds
  s_mov_b64 exec, -1
  s_mov_b32 s30, 256
  s_mov_b32 s31, 163840
  s_add_u32 m0, s28, 36864
  s_nop 0
  buffer_load_dwordx4 v2, s[8:11], s30 offen lds
  s_add_u32 m0, s29, 36864
  s_nop 0
  buffer_load_dwordx4 v4, s[12:15], s31 offen lds
  s_add_u32 m0, s29, 37888
  s_mov_b64 exec, 0xffff
  buffer_load_dwordx4 v5, s[12:15], s31 offen lds
  s_mov_b64 exec, -1
  s_mov_b32 s30, 384
  s_mov_b32 s31, 245760
  s_add_u32 m0, s28, 55296
  s_nop 0
  buffer_load_dwordx4 v2, s[8:11], s30 offen lds
  s_add_u32 m0, s29, 55296
  s_nop 0
  buffer_load_dwordx4 v4, s[12:15], s31 offen lds
  s_add_u32 m0, s29, 56320
  s_mov_b64 exec, 0xffff
  buffer_load_dwordx4 v5, s[12:15], s31 offen lds
  s_mov_b64 exec, -1
  s_cmp_eq_u32 s6, 0
  s_cbranch_scc0 L_pfw_5
  v_min_u32 v20, 47, v0
  v_mul_u32_u24 v21, 10923, v20
  v_lshrrev_b32 v21, 16, v21
  v_mul_u32_u24 v22, 6, v21
  v_sub_u32 v22, v20, v22
  v_mul_u32_u24 v21, 1280, v21
  v_lshl_add_u32 v21, v22, 7, v21
  s_lshl_b32 s32, s24, 3
  s_add_u32 s32, s32, s25
  s_mul_i32 s32, s32, 10240
  s_add_u32 s32, s32, 512
  buffer_load_dword v7, v21, s[8:11], s32 offen
  s_branch L_pfd_7
L_pfw_5:
  s_cmp_ge_u32 s6, 4
  s_cbranch_scc1 L_pf7_6
  s_sub_u32 s7, s6, 1
  s_lshl_b32 s7, s7, 6
  v_add_u32 v20, s7, v0
  v_lshrrev_b32 v21, 1, v20
  v_and_b32 v22, 1, v20
  v_mul_u32_u24 v21, 5120, v21
  v_lshl_add_u32 v21, v22, 7, v21
  s_lshr_b32 s32, s24, 3
  s_add_u32 s32, s32, 256
  s_mul_i32 s32, s32, 1280
  s_mul_i32 s33, s25, 160
  s_and_b32 s33, s33, 0xffffff80
  s_add_u32 s32, s32, s33
  buffer_load_dword v7, v21, s[12:15], s32 offen
  s_branch L_pfd_7
L_pf7_6:
  v_mov_b32 v21, 0
  buffer_load_dword v7, v21, s[12:15], 0 offen
L_pfd_7:
  v_mov_b32 v28, 0
  buffer_load_dword v29, v28, s[20:23], 0 offen sc1
  v_and_b32 v20, 31, v0
  s_lshl_b32 s7, s27, 5
  v_add_u32 v20, s7, v20
  v_bfe_u32 v22, v20, 1, 3
  v_lshlrev_b32 v20, 7, v20
  v_lshrrev_b32 v21, 5, v0
  v_xor_b32 v21, v21, v22
  v_xor_b32 v22, 0, v21
  v_lshl_add_u32 v8, v22, 4, v20
  v_xor_b32 v22, 2, v21
  v_lshl_add_u32 v9, v22, 4, v20
  v_xor_b32 v22, 4, v21
  v_lshl_add_u32 v10, v22, 4, v20
  v_xor_b32 v22, 6, v21
  v_lshl_add_u32 v11, v22, 4, v20
  v_lshrrev_b32 v20, 5, v0
  v_lshlrev_b32 v20, 3, v20
  v_bfe_u32 v21, v0, 2, 2
  v_add_u32 v20, v20, v21
  v_bfe_u32 v21, v0, 4, 1
  v_lshlrev_b32 v21, 5, v21
  v_and_b32 v22, 3, v0
  v_lshl_add_u32 v21, v22, 3, v21
  v_mul_u32_u24 v22, 160, v20
  v_add_u32 v22, v22, v21
  s_mul_i32 s7, s26, 40
  s_add_u32 s7, s7, 8192
  v_add_u32 v16, s7, v22
  v_mul_u32_u24 v22, 40, v20
  v_add_u32 v22, v22, v21
  v_mov_b32 v17, v22
  v_mov_b32 v20, 81440
  v_mov_b32 v21, 0
  ds_write_b32 v20, v21
  s_waitcnt lgkmcnt(0)
  s_waitcnt vmcnt(11)
  s_barrier
  ds_read_b64_tr_b16 v[48:49], v16 offset:0
  ds_read_b64_tr_b16 v[50:51], v16 offset:640
  ds_read_b128 v[52:55], v8 offset:0
  ds_read_b64_tr_b16 v[56:57], v16 offset:2560
  ds_read_b64_tr_b16 v[58:59], v16 offset:3200
  ds_read_b128 v[60:63], v9 offset:0
  s_waitcnt lgkmcnt(3)
  v_mfma_f32_32x32x16_bf16 v[32:47], v[48:51], v[52:55], 0
  ds_read_b64_tr_b16 v[48:49], v16 offset:5120
  ds_read_b64_tr_b16 v[50:51], v16 offset:5760
  ds_read_b128 v[52:55], v10 offset:0
  s_waitcnt lgkmcnt(3)
  v_mfma_f32_32x32x16_bf16 v[32:47], v[56:59], v[60:63], v[32:47]
  s_waitcnt vmcnt(8)
  s_barrier
  ds_read_b64_tr_b16 v[56:57], v16 offset:7680
  ds_read_b64_tr_b16 v[58:59], v16 offset:8320
  ds_read_b128 v[60:63], v11 offset:0
  s_waitcnt lgkmcnt(3)
  v_mfma_f32_32x32x16_bf16 v[32:47], v[48:51], v[52:55], v[32:47]
  ds_read_b64_tr_b16 v[48:49], v16 offset:18432
  ds_read_b64_tr_b16 v[50:51], v16 offset:19072
  ds_read_b128 v[52:55], v8 offset:18432
  s_waitcnt lgkmcnt(3)
  v_mfma_f32_32x32x16_bf16 v[32:47], v[56:59], v[60:63], v[32:47]
  ds_read_b64_tr_b16 v[56:57], v16 offset:20992
  ds_read_b64_tr_b16 v[58:59], v16 offset:21632
  ds_read_b128 v[60:63], v9 offset:18432
  s_waitcnt lgkmcnt(3)
  v_mfma_f32_32x32x16_bf16 v[32:47], v[48:51], v[52:55], v[32:47]
  ds_read_b64_tr_b16 v[48:49], v16 offset:23552
  ds_read_b64_tr_b16 v[50:51], v16 offset:24192
  ds_read_b128 v[52:55], v10 offset:18432
  s_waitcnt lgkmcnt(3)
  v_mfma_f32_32x32x16_bf16 v[32:47], v[56:59], v[60:63], v[32:47]
  s_waitcnt vmcnt(5)
  s_barrier
  s_mov_b32 s30, 512
  s_mov_b32 s31, 327680
  s_add_u32 m0, s28, 0
  s_nop 0
  buffer_load_dwordx4 v2, s[8:11], s30 offen lds
  s_add_u32 m0, s29, 0
  s_nop 0
  buffer_load_dwordx4 v4, s[12:15], s31 offen lds
  s_add_u32 m0, s29, 1024
  s_mov_b64 exec, 0xffff
  buffer_load_dwordx4 v5, s[12:15], s31 offen lds
  s_mov_b64 exec, -1
  ds_read_b64_tr_b16 v[56:57], v16 offset:26112
  ds_read_b64_tr_b16 v[58:59], v16 offset:26752
  ds_read_b128 v[60:63], v11 offset:18432
  s_waitcnt lgkmcnt(3)
  v_mfma_f32_32x32x16_bf16 v[32:47], v[48:51], v[52:55], v[32:47]
  ds_read_b64_tr_b16 v[48:49], v16 offset:36864
  ds_read_b64_tr_b16 v[50:51], v16 offset:37504
  ds_read_b128 v[52:55], v8 offset:36864
  s_waitcnt lgkmcnt(3)
  v_mfma_f32_32x32x16_bf16 v[32:47], v[56:59], v[60:63], v[32:47]
  ds_read_b64_tr_b16 v[56:57], v16 offset:39424
  ds_read_b64_tr_b16 v[58:59], v16 offset:40064
  ds_read_b128 v[60:63], v9 offset:36864
  s_waitcnt lgkmcnt(3)
  v_mfma_f32_32x32x16_bf16 v[32:47], v[48:51], v[52:55], v[32:47]
  ds_read_b64_tr_b16 v[48:49], v16 offset:41984
  ds_read_b64_tr_b16 v[50:51], v16 offset:42624
  ds_read_b128 v[52:55], v10 offset:36864
  s_waitcnt lgkmcnt(3)
  v_mfma_f32_32x32x16_bf16 v[32:47], v[56:59], v[60:63], v[32:47]
  s_waitcnt vmcnt(5)
  s_barrier
  s_mov_b32 s30, 640
  s_mov_b32 s31, 409600
  s_add_u32 m0, s28, 18432
  s_nop 0
  buffer_load_dwordx4 v2, s[8:11], s30 offen lds
  s_add_u32 m0, s29, 18432
  s_nop 0
  buffer_load_dwordx4 v4, s[12:15], s31 offen lds
  s_add_u32 m0, s29, 19456
  s_mov_b64 exec, 0xffff
  buffer_load_dwordx4 v5, s[12:15], s31 offen lds
  s_mov_b64 exec, -1
  ds_read_b64_tr_b16 v[56:57], v16 offset:44544
  ds_read_b64_tr_b16 v[58:59], v16 offset:45184
  ds_read_b128 v[60:63], v11 offset:36864
  s_waitcnt lgkmcnt(3)
  v_mfma_f32_32x32x16_bf16 v[32:47], v[48:51], v[52:55], v[32:47]
  ds_read_b64_tr_b16 v[48:49], v16 offset:55296
  ds_read_b64_tr_b16 v[50:51], v16 offset:55936
  ds_read_b128 v[52:55], v8 offset:55296
  s_waitcnt lgkmcnt(3)
  v_mfma_f32_32x32x16_bf16 v[32:47], v[56:59], v[60:63], v[32:47]
  ds_read_b64_tr_b16 v[56:57], v16 offset:57856
  ds_read_b64_tr_b16 v[58:59], v16 offset:58496
  ds_read_b128 v[60:63], v9 offset:55296
  s_waitcnt lgkmcnt(3)
  v_mfma_f32_32x32x16_bf16 v[32:47], v[48:51], v[52:55], v[32:47]
  ds_read_b64_tr_b16 v[48:49], v16 offset:60416
  ds_read_b64_tr_b16 v[50:51], v16 offset:61056
  ds_read_b128 v[52:55], v10 offset:55296
  s_waitcnt lgkmcnt(3)
  v_mfma_f32_32x32x16_bf16 v[32:47], v[56:59], v[60:63], v[32:47]
  s_waitcnt vmcnt(3)
  s_barrier
  s_mov_b32 s30, 768
  s_mov_b32 s31, 491520
  s_add_u32 m0, s28, 36864
  s_nop 0
  buffer_load_dwordx4 v2, s[8:11], s30 offen lds
  s_add_u32 m0, s29, 36864
  s_nop 0
  buffer_load_dwordx4 v4, s[12:15], s31 offen lds
  s_add_u32 m0, s29, 37888
  s_mov_b64 exec, 0xffff
  buffer_load_dwordx4 v5, s[12:15], s31 offen lds
  s_mov_b64 exec, -1
  ds_read_b64_tr_b16 v[56:57], v16 offset:62976
  ds_read_b64_tr_b16 v[58:59], v16 offset:63616
  ds_read_b128 v[60:63], v11 offset:55296
  s_waitcnt lgkmcnt(3)
  v_mfma_f32_32x32x16_bf16 v[32:47], v[48:51], v[52:55], v[32:47]
  ds_read_b64_tr_b16 v[48:49], v16 offset:0
  ds_read_b64_tr_b16 v[50:51], v16 offset:640
  ds_read_b128 v[52:55], v8 offset:0
  s_waitcnt lgkmcnt(3)
  v_mfma_f32_32x32x16_bf16 v[32:47], v[56:59], v[60:63], v[32:47]
  ds_read_b64_tr_b16 v[56:57], v16 offset:2560
  ds_read_b64_tr_b16 v[58:59], v16 offset:3200
  ds_read_b128 v[60:63], v9 offset:0
  s_waitcnt lgkmcnt(3)
  v_mfma_f32_32x32x16_bf16 v[32:47], v[48:51], v[52:55], v[32:47]
  ds_read_b64_tr_b16 v[48:49], v16 offset:5120
  ds_read_b64_tr_b16 v[50:51], v16 offset:5760
  ds_read_b128 v[52:55], v10 offset:0
  s_waitcnt lgkmcnt(3)
  v_mfma_f32_32x32x16_bf16 v[32:47], v[56:59], v[60:63], v[32:47]
  s_waitcnt vmcnt(3)
  s_barrier
  s_mov_b32 s30, 896
  s_mov_b32 s31, 573440
  s_add_u32 m0, s28, 55296
  s_nop 0
  buffer_load_dwordx4 v2, s[8:11], s30 offen lds
  s_add_u32 m0, s29, 55296
  s_nop 0
  buffer_load_dwordx4 v4, s[12:15], s31 offen lds
  s_add_u32 m0, s29, 56320
  s_mov_b64 exec, 0xffff
  buffer_load_dwordx4 v5, s[12:15], s31 offen lds
  s_mov_b64 exec, -1
  ds_read_b64_tr_b16 v[56:57], v16 offset:7680
  ds_read_b64_tr_b16 v[58:59], v16 offset:8320
  ds_read_b128 v[60:63], v11 offset:0
  s_waitcnt lgkmcnt(3)
  v_mfma_f32_32x32x16_bf16 v[32:47], v[48:51], v[52:55], v[32:47]
  ds_read_b64_tr_b16 v[48:49], v16 offset:18432
  ds_read_b64_tr_b16 v[50:51], v16 offset:19072
  ds_read_b128 v[52:55], v8 offset:18432
  s_waitcnt lgkmcnt(3)
  v_mfma_f32_32x32x16_bf16 v[32:47], v[56:59], v[60:63], v[32:47]
  ds_read_b64_tr_b16 v[56:57], v16 offset:20992
  ds_read_b64_tr_b16 v[58:59], v16 offset:21632
  ds_read_b128 v[60:63], v9 offset:18432
  s_waitcnt lgkmcnt(3)
  v_mfma_f32_32x32x16_bf16 v[32:47], v[48:51], v[52:55], v[32:47]
  ds_read_b64_tr_b16 v[48:49], v16 offset:23552
  ds_read_b64_tr_b16 v[50:51], v16 offset:24192
  ds_read_b128 v[52:55], v10 offset:18432
  s_waitcnt lgkmcnt(3)
  v_mfma_f32_32x32x16_bf16 v[32:47], v[56:59], v[60:63], v[32:47]
  s_waitcnt vmcnt(3)
  s_barrier
  s_mov_b32 s30, 1024
  s_mov_b32 s31, 655360
  s_add_u32 m0, s28, 0
  s_nop 0
  buffer_load_dwordx4 v2, s[8:11], s30 offen lds
  s_add_u32 m0, s29, 0
  s_nop 0
  buffer_load_dwordx4 v4, s[12:15], s31 offen lds
  s_add_u32 m0, s29, 1024
  s_mov_b64 exec, 0xffff
  buffer_load_dwordx4 v5, s[12:15], s31 offen lds
  s_mov_b64 exec, -1
  ds_read_b64_tr_b16 v[56:57], v16 offset:26112
  ds_read_b64_tr_b16 v[58:59], v16 offset:26752
  ds_read_b128 v[60:63], v11 offset:18432
  s_waitcnt lgkmcnt(3)
  v_mfma_f32_32x32x16_bf16 v[32:47], v[48:51], v[52:55], v[32:47]
  ds_read_b64_tr_b16 v[48:49], v16 offset:36864
  ds_read_b64_tr_b16 v[50:51], v16 offset:37504
  ds_read_b128 v[52:55], v8 offset:36864
  s_waitcnt lgkmcnt(3)
  v_mfma_f32_32x32x16_bf16 v[32:47], v[56:59], v[60:63], v[32:47]
  ds_read_b64_tr_b16 v[56:57], v16 offset:39424
  ds_read_b64_tr_b16 v[58:59], v16 offset:40064
  ds_read_b128 v[60:63], v9 offset:36864
  s_waitcnt lgkmcnt(3)
  v_mfma_f32_32x32x16_bf16 v[32:47], v[48:51], v[52:55], v[32:47]
  ds_read_b64_tr_b16 v[48:49], v16 offset:41984
  ds_read_b64_tr_b16 v[50:51], v16 offset:42624
  ds_read_b128 v[52:55], v10 offset:36864
  s_waitcnt lgkmcnt(3)
  v_mfma_f32_32x32x16_bf16 v[32:47], v[56:59], v[60:63], v[32:47]
  s_waitcnt vmcnt(3)
  s_barrier
  s_mov_b32 s30, 1152
  s_mov_b32 s31, 737280
  s_add_u32 m0, s28, 18432
  s_nop 0
  buffer_load_dwordx4 v2, s[8:11], s30 offen lds
  s_add_u32 m0, s29, 18432
  s_nop 0
  buffer_load_dwordx4 v4, s[12:15], s31 offen lds
  s_add_u32 m0, s29, 19456
  s_mov_b64 exec, 0xffff
  buffer_load_dwordx4 v5, s[12:15], s31 offen lds
  s_mov_b64 exec, -1
  s_and_b32 s7, s3, 7
  s_lshl_b32 s7, s7, 10
  s_add_u32 s7, s7, 8650752
  v_lshlrev_b32 v24, 4, v0
  v_add_u32 v24, s7, v24
  s_cmp_eq_u32 s6, 0
  s_cselect_b32 exec_hi, -1, 0
  s_cselect_b32 exec_lo, -1, 1
  buffer_load_dwordx4 v[12:15], v24, s[16:19], 0 offen sc1
  s_mov_b64 exec, -1
  s_mul_i32 s40, s6, 3072
  v_lshlrev_b32 v1, 4, v0
  v_add_u32 v1, s40, v1
  ds_read_b64_tr_b16 v[56:57], v16 offset:44544
  ds_read_b64_tr_b16 v[58:59], v16 offset:45184
  ds_read_b128 v[60:63], v11 offset:36864
  s_waitcnt lgkmcnt(3)
  v_mfma_f32_32x32x16_bf16 v[32:47], v[48:51], v[52:55], v[32:47]
  ds_read_b64_tr_b16 v[48:49], v16 offset:55296
  ds_read_b64_tr_b16 v[50:51], v16 offset:55936
  ds_read_b128 v[52:55], v8 offset:55296
  s_waitcnt lgkmcnt(3)
  v_mfma_f32_32x32x16_bf16 v[32:47], v[56:59], v[60:63], v[32:47]
  ds_read_b64_tr_b16 v[56:57], v16 offset:57856
  ds_read_b64_tr_b16 v[58:59], v16 offset:58496
  ds_read_b128 v[60:63], v9 offset:55296
  s_waitcnt lgkmcnt(3)
  v_mfma_f32_32x32x16_bf16 v[32:47], v[48:51], v[52:55], v[32:47]
  ds_read_b64_tr_b16 v[48:49], v16 offset:60416
  ds_read_b64_tr_b16 v[50:51], v16 offset:61056
  ds_read_b128 v[52:55], v10 offset:55296
  s_waitcnt lgkmcnt(3)
  v_mfma_f32_32x32x16_bf16 v[32:47], v[56:59], v[60:63], v[32:47]
  s_waitcnt vmcnt(4)
  s_barrier
  ds_read_b64_tr_b16 v[56:57], v16 offset:62976
  ds_read_b64_tr_b16 v[58:59], v16 offset:63616
  ds_read_b128 v[60:63], v11 offset:55296
  s_waitcnt lgkmcnt(3)
  v_mfma_f32_32x32x16_bf16 v[32:47], v[48:51], v[52:55], v[32:47]
  ds_read_b64_tr_b16 v[48:49], v16 offset:0
  ds_read_b64_tr_b16 v[50:51], v16 offset:640
  ds_read_b128 v[52:55], v8 offset:0
  s_waitcnt lgkmcnt(3)
  v_mfma_f32_32x32x16_bf16 v[32:47], v[56:59], v[60:63], v[32:47]
  ds_read_b64_tr_b16 v[56:57], v16 offset:2560
  ds_read_b64_tr_b16 v[58:59], v16 offset:3200
  ds_read_b128 v[60:63], v9 offset:0
  s_waitcnt lgkmcnt(3)
  v_mfma_f32_32x32x16_bf16 v[32:47], v[48:51], v[52:55], v[32:47]
  ds_read_b64_tr_b16 v[48:49], v16 offset:5120
  ds_read_b64_tr_b16 v[50:51], v16 offset:5760
  ds_read_b128 v[52:55], v10 offset:0
  s_waitcnt lgkmcnt(3)
  v_mfma_f32_32x32x16_bf16 v[32:47], v[56:59], v[60:63], v[32:47]
  s_waitcnt vmcnt(1)
  s_waitcnt vmcnt(0)
  v_readfirstlane_b32 s43, v29
  s_cmp_lg_u32 s6, 0
  s_cbranch_scc1 L_notyet_8
  s_cmp_eq_u32 s43, 0
  s_cbranch_scc1 L_notyet_8
  v_xor_b32 v12, s43, v12
  v_xor_b32 v13, s43, v13
  v_xor_b32 v14, s43, v14
  v_xor_b32 v15, s43, v15
  v_or_b32 v12, v12, v13
  v_or_b32 v14, v14, v15
  v_or_b32 v12, v12, v14
  v_cmp_ne_u32 vcc, 0, v12
  s_nop 1
  s_cmp_lg_u64 vcc, 0
  s_cbranch_scc1 L_notyet_8
  v_mov_b32 v24, 81440
  v_mov_b32 v25, s43
  ds_write_b32 v24, v25
  s_waitcnt lgkmcnt(0)
L_notyet_8:
  s_barrier
  v_mov_b32 v24, 81440
  ds_read_b32 v25, v24
  s_waitcnt lgkmcnt(0)
  v_readfirstlane_b32 s59, v25
  s_nop 1
  s_cmp_eq_u32 s59, 0
  s_cbranch_scc1 L_notyet_9
  s_mov_b32 s43, s59
  v_lshlrev_b32 v27, 3, v0
  s_mov_b32 s7, 227328
  buffer_load_dwordx2 v[26:27], v27, s[16:19], s7 offen sc1
  s_mov_b32 s32, 0
  s_mov_b32 s33, 49152
  s_add_u32 m0, s33, s40
  s_nop 0
  buffer_load_dwordx4 v1, s[16:19], s32 offen offset:0 sc1 lds
  buffer_load_dwordx4 v1, s[16:19], s32 offen offset:1024 sc1 lds
  buffer_load_dwordx4 v1, s[16:19], s32 offen offset:2048 sc1 lds
L_notyet_9:
  ds_read_b64_tr_b16 v[56:57], v16 offset:7680
  ds_read_b64_tr_b16 v[58:59], v16 offset:8320
  ds_read_b128 v[60:63], v11 offset:0
  s_waitcnt lgkmcnt(3)
  v_mfma_f32_32x32x16_bf16 v[32:47], v[48:51], v[52:55], v[32:47]
  ds_read_b64_tr_b16 v[48:49], v16 offset:18432
  ds_read_b64_tr_b16 v[50:51], v16 offset:19072
  ds_read_b128 v[52:55], v8 offset:18432
  s_waitcnt lgkmcnt(3)
  v_mfma_f32_32x32x16_bf16 v[32:47], v[56:59], v[60:63], v[32:47]
  ds_read_b64_tr_b16 v[56:57], v16 offset:20992
  ds_read_b64_tr_b16 v[58:59], v16 offset:21632
  ds_read_b128 v[60:63], v9 offset:18432
  s_waitcnt lgkmcnt(3)
  v_mfma_f32_32x32x16_bf16 v[32:47], v[48:51], v[52:55], v[32:47]
  ds_read_b64_tr_b16 v[48:49], v16 offset:23552
  ds_read_b64_tr_b16 v[50:51], v16 offset:24192
  ds_read_b128 v[52:55], v10 offset:18432
  s_waitcnt lgkmcnt(3)
  v_mfma_f32_32x32x16_bf16 v[32:47], v[56:59], v[60:63], v[32:47]
  ds_read_b64_tr_b16 v[56:57], v16 offset:26112
  ds_read_b64_tr_b16 v[58:59], v16 offset:26752
  ds_read_b128 v[60:63], v11 offset:18432
  s_waitcnt lgkmcnt(3)
  v_mfma_f32_32x32x16_bf16 v[32:47], v[48:51], v[52:55], v[32:47]
  s_waitcnt lgkmcnt(0)
  v_mfma_f32_32x32x16_bf16 v[32:47], v[56:59], v[60:63], v[32:47]
  s_barrier
  s_nop 11
  s_mov_b32 s7, 0x3ea52b5c
  v_mul_f32 v32, s7, v32
  v_mul_f32 v33, s7, v33
  v_mul_f32 v34, s7, v34
  v_mul_f32 v35, s7, v35
  v_mul_f32 v36, s7, v36
  v_mul_f32 v37, s7, v37
  v_mul_f32 v38, s7, v38
  v_mul_f32 v39, s7, v39
  v_mul_f32 v40, s7, v40
  v_mul_f32 v41, s7, v41
  v_mul_f32 v42, s7, v42
  v_mul_f32 v43, s7, v43
  s_mov_b32 exec_lo, 0
  v_mov_b32 v40, 0
  v_mov_b32 v41, 0
  v_mov_b32 v42, 0
  v_mov_b32 v43, 0
  s_mov_b32 exec_lo, -1
  v_mul_f32 v19, v32, v32
  v_fmac_f32 v19, v33, v33
  v_fmac_f32 v19, v34, v34
  v_fmac_f32 v19, v35, v35
  v_fmac_f32 v19, v36, v36
  v_fmac_f32 v19, v37, v37
  v_fmac_f32 v19, v38, v38
  v_fmac_f32 v19, v39, v39
  v_fmac_f32 v19, v40, v40
  v_fmac_f32 v19, v41, v41
  v_fmac_f32 v19, v42, v42
  v_fmac_f32 v19, v43, v43
  v_cvt_pk_bf16_f32 v72, v32, v33
  v_cvt_pk_bf16_f32 v73, v34, v35
  v_cvt_pk_bf16_f32 v74, v36, v37
  v_cvt_pk_bf16_f32 v75, v38, v39
  v_cvt_pk_bf16_f32 v76, v40, v41
  v_cvt_pk_bf16_f32 v77, v42, v43
  v_mov_b32 v24, v19
  s_nop 1
  v_permlane32_swap_b32 v19, v24
  s_nop 0
  v_add_f32 v19, v19, v24
  s_cmp_lg_u32 s59, 0
  s_cbranch_scc1 L_kv_rdy_10
  s_waitcnt vmcnt(0)
  s_cmp_lg_u32 s6, 0
  s_cbranch_scc1 L_b1_other_12
  s_mov_b32 s36, 0
L_nonce_14:
  v_readfirstlane_b32 s43, v29
  s_nop 1
  s_cmp_lg_u32 s43, 0
  s_cbranch_scc1 L_nonce_ok_15
  s_add_u32 s36, s36, 1
  s_cmp_gt_u32 s36, 20000
  s_cbranch_scc1 L_nonce_ok_15
  s_sleep 4
  v_mov_b32 v28, 0
  buffer_load_dword v29, v28, s[20:23], 0 offen sc1
  s_waitcnt vmcnt(0)
  s_branch L_nonce_14
L_nonce_ok_15:
  s_and_b32 s7, s3, 7
  s_lshl_b32 s7, s7, 10
  s_add_u32 s7, s7, 8650752
  v_lshlrev_b32 v24, 4, v0
  v_add_u32 v24, s7, v24
  s_mov_b32 s36, 0
L_poll_b1_16:
  buffer_load_dwordx4 v[12:15], v24, s[16:19], 0 offen sc1
  s_add_u32 s36, s36, 1
  s_waitcnt vmcnt(0)
  v_xor_b32 v12, s43, v12
  v_xor_b32 v13, s43, v13
  v_xor_b32 v14, s43, v14
  v_xor_b32 v15, s43, v15
  v_or_b32 v12, v12, v13
  v_or_b32 v14, v14, v15
  v_or_b32 v12, v12, v14
  v_cmp_ne_u32 s[34:35], 0, v12
  s_nop 1
  s_cmp_eq_u64 s[34:35], 0
  s_cbranch_scc1 L_pollout_b1_17
  s_cmp_gt_u32 s36, 20000
  s_cbranch_scc1 L_pollout_b1_17
  s_sleep 8
  s_branch L_poll_b1_16
L_pollout_b1_17:
  v_mov_b32 v24, 81440
  v_mov_b32 v25, s43
  ds_write_b32 v24, v25
  s_branch L_b1_go_13
L_b1_other_12:
  v_mov_b32 v24, 81440
  s_mov_b32 s36, 0
L_b1_spin_19:
  ds_read_b32 v25, v24
  s_add_u32 s36, s36, 1
  s_waitcnt lgkmcnt(0)
  v_readfirstlane_b32 s43, v25
  s_nop 1
  s_cmp_lg_u32 s43, 0
  s_cbranch_scc1 L_b1_go_13
  s_cmp_gt_u32 s36, 160000
  s_cbranch_scc1 L_b1_go_13
  s_sleep 2
  s_branch L_b1_spin_19
L_b1_go_13:
  v_lshlrev_b32 v27, 3, v0
  s_mov_b32 s7, 227328
  buffer_load_dwordx2 v[26:27], v27, s[16:19], s7 offen sc1
  s_mov_b32 s32, 0
  s_mov_b32 s33, 49152
  s_add_u32 m0, s33, s40
  s_nop 0
  buffer_load_dwordx4 v1, s[16:19], s32 offen offset:0 sc1 lds
  buffer_load_dwordx4 v1, s[16:19], s32 offen offset:1024 sc1 lds
  buffer_load_dwordx4 v1, s[16:19], s32 offen offset:2048 sc1 lds
L_kv_rdy_10:
  s_mov_b32 s32, 24576
  s_mov_b32 s33, 0
  s_add_u32 m0, s33, s40
  s_nop 0
  buffer_load_dwordx4 v1, s[16:19], s32 offen offset:0 sc1 lds
  buffer_load_dwordx4 v1, s[16:19], s32 offen offset:1024 sc1 lds
  buffer_load_dwordx4 v1, s[16:19], s32 offen offset:2048 sc1 lds
  s_mov_b32 s42, 0
  s_waitcnt vmcnt(6)
  v_max_f32 v27, v26, v27
  s_nop 1
  v_max_f32_dpp v27, v27, v27 row_shr:1 row_mask:0xf bank_mask:0xf
  s_nop 1
  v_max_f32_dpp v27, v27, v27 row_shr:2 row_mask:0xf bank_mask:0xf
  s_nop 1
  v_max_f32_dpp v27, v27, v27 row_shr:4 row_mask:0xf bank_mask:0xf
  s_nop 1
  v_max_f32_dpp v27, v27, v27 row_shr:8 row_mask:0xf bank_mask:0xf
  s_nop 1
  v_max_f32_dpp v27, v27, v27 row_bcast:15 row_mask:0xa bank_mask:0xf
  s_nop 1
  v_max_f32_dpp v27, v27, v27 row_bcast:31 row_mask:0xc bank_mask:0xf
  s_nop 1
  v_readlane_b32 s7, v27, 63
  s_nop 1
  v_mul_f32 v24, s7, v19
  v_sqrt_f32 v24, v24
  s_mov_b32 s7, 0x3f828f5c
  s_nop 0
  v_mul_f32 v24, s7, v24
  v_cvt_pk_bf16_f32 v25, -v24, 0
  s_mov_b32 exec_lo, 0
  v_mov_b32 v76, v25
  s_mov_b32 exec_lo, -1
  s_mul_i32 s7, s6, 1536
  s_add_u32 s7, s7, 24576
  v_lshlrev_b32 v24, 4, v0
  v_add_u32 v24, s7, v24
  ds_write_b128 v24, v[72:75]
  v_lshlrev_b32 v25, 3, v0
  v_add_u32 v25, s7, v25
  ds_write_b64 v25, v[76:77] offset:1024
  s_mul_i32 s7, s27, 12288
  v_lshlrev_b32 v2, 4, v0
  v_add_u32 v2, s7, v2
  v_lshlrev_b32 v3, 3, v0
  v_add_u32 v3, s7, v3
  v_and_b32 v5, 31, v0
  v_min_u32 v5, 23, v5
  v_lshrrev_b32 v6, 5, v0
  v_mul_u32_u24 v6, 24, v6
  v_add_u32 v5, v5, v6
  v_lshlrev_b32 v4, 4, v5
  v_add_u32 v4, s7, v4
  s_waitcnt vmcnt(3) lgkmcnt(0)
  s_barrier
  s_mul_i32 s7, s26, 1536
  s_add_u32 s7, s7, 24576
  v_lshlrev_b32 v5, 4, v0
  v_add_u32 v5, s7, v5
  v_lshlrev_b32 v6, 3, v0
  v_add_u32 v6, s7, v6
  ds_read_b128 v[88:91], v5 offset:0
  ds_read_b64 v[92:93], v6 offset:1024
  ds_read_b128 v[94:97], v5 offset:6144
  ds_read_b64 v[98:99], v6 offset:7168
  s_branch L_attn_first_21
L_attn_start_20:
  s_mov_b32 s32, 0
  s_mov_b32 s33, 49152
  s_add_u32 m0, s33, s40
  s_nop 0
  buffer_load_dwordx4 v1, s[16:19], s32 offen offset:0 sc1 lds
  buffer_load_dwordx4 v1, s[16:19], s32 offen offset:1024 sc1 lds
  buffer_load_dwordx4 v1, s[16:19], s32 offen offset:2048 sc1 lds
  s_mov_b32 s32, 24576
  s_mov_b32 s33, 0
  s_add_u32 m0, s33, s40
  s_nop 0
  buffer_load_dwordx4 v1, s[16:19], s32 offen offset:0 sc1 lds
  buffer_load_dwordx4 v1, s[16:19], s32 offen offset:1024 sc1 lds
  buffer_load_dwordx4 v1, s[16:19], s32 offen offset:2048 sc1 lds
  s_mul_i32 s7, s27, 12288
  v_lshlrev_b32 v2, 4, v0
  v_add_u32 v2, s7, v2
  v_lshlrev_b32 v3, 3, v0
  v_add_u32 v3, s7, v3
  v_and_b32 v5, 31, v0
  v_min_u32 v5, 23, v5
  v_lshrrev_b32 v6, 5, v0
  v_mul_u32_u24 v6, 24, v6
  v_add_u32 v5, v5, v6
  v_lshlrev_b32 v4, 4, v5
  v_add_u32 v4, s7, v4
  s_waitcnt vmcnt(3)
  s_barrier
L_attn_first_21:
  ds_read_b128 v[100:103], v2 offset:49152
  ds_read_b64 v[104:105], v3 offset:50176
  ds_read_b128 v[112:115], v4 offset:50688
  ds_read_b128 v[120:123], v4 offset:51456
  v_mov_b32 v16, 0
  v_mov_b32 v17, 0
  v_mov_b32 v18, 0
  v_mov_b32 v19, 0
  v_mov_b32 v20, 0
  v_mov_b32 v21, 0
  v_mov_b32 v22, 0
  v_mov_b32 v23, 0
  v_mov_b32 v24, 0
  v_mov_b32 v25, 0
  v_mov_b32 v26, 0
  v_mov_b32 v27, 0
  v_mov_b32 v28, 0
  v_mov_b32 v29, 0
  v_mov_b32 v30, 0
  v_mov_b32 v31, 0
  v_mov_b32 v32, 0
  v_mov_b32 v33, 0
  v_mov_b32 v34, 0
  v_mov_b32 v35, 0
  v_mov_b32 v36, 0
  v_mov_b32 v37, 0
  v_mov_b32 v38, 0
  v_mov_b32 v39, 0
  v_mov_b32 v40, 0
  v_mov_b32 v41, 0
  v_mov_b32 v42, 0
  v_mov_b32 v43, 0
  v_mov_b32 v44, 0
  v_mov_b32 v45, 0
  v_mov_b32 v46, 0
  v_mov_b32 v47, 0
  v_mov_b32 v84, 0
  v_mov_b32 v85, 0
  v_mov_b32 v86, 0
  v_mov_b32 v87, 0
  v_mov_b32 v124, 0
  v_mov_b32 v125, 0
  v_mov_b32 v126, 0
  v_mov_b32 v127, 0
  s_mov_b32 s41, 49152
  s_waitcnt lgkmcnt(2)
  v_mfma_f32_32x32x16_bf16 v[48:63], v[100:103], v[88:91], 0
  v_mfma_f32_32x32x8_bf16 v[48:63], v[104:105], v[92:93], v[48:63]
  s_nop 11
.p2align 6
L_chunk3_22:
  s_waitcnt lgkmcnt(0)
  v_mfma_f32_32x32x16_bf16 v[64:79], v[100:103], v[94:97], 0
  v_exp_f32 v48, v48
  v_exp_f32 v49, v49
  v_exp_f32 v50, v50
  v_exp_f32 v51, v51
  v_cvt_pk_bf16_f32 v80, v48, v49
  v_cvt_pk_bf16_f32 v81, v50, v51
  v_mfma_f32_32x32x16_bf16 v[32:47], v[124:127], v[84:87], v[32:47]
  ds_read_b128 v[106:109], v2 offset:52224
  ds_read_b64 v[110:111], v3 offset:53248
  v_exp_f32 v52, v52
  v_exp_f32 v53, v53
  v_exp_f32 v54, v54
  v_exp_f32 v55, v55
  v_cvt_pk_bf16_f32 v82, v52, v53
  v_cvt_pk_bf16_f32 v83, v54, v55
  v_mfma_f32_32x32x8_bf16 v[64:79], v[104:105], v[98:99], v[64:79]
  v_exp_f32 v56, v56
  v_exp_f32 v57, v57
  v_exp_f32 v58, v58
  v_exp_f32 v59, v59
  v_cvt_pk_bf16_f32 v84, v56, v57
  v_cvt_pk_bf16_f32 v85, v58, v59
  v_mfma_f32_32x32x16_bf16 v[16:31], v[112:115], v[80:83], v[16:31]
  v_exp_f32 v60, v60
  v_exp_f32 v61, v61
  v_exp_f32 v62, v62
  v_exp_f32 v63, v63
  v_cvt_pk_bf16_f32 v86, v60, v61
  v_cvt_pk_bf16_f32 v87, v62, v63
  s_waitcnt lgkmcnt(0)
  v_mfma_f32_32x32x16_bf16 v[48:63], v[106:109], v[88:91], 0
  v_exp_f32 v64, v64
  v_exp_f32 v65, v65
  v_exp_f32 v66, v66
  v_exp_f32 v67, v67
  v_cvt_pk_bf16_f32 v80, v64, v65
  v_cvt_pk_bf16_f32 v81, v66, v67
  v_mfma_f32_32x32x16_bf16 v[16:31], v[120:123], v[84:87], v[16:31]
  ds_read_b128 v[116:119], v4 offset:53760
  ds_read_b128 v[124:127], v4 offset:54528
  v_exp_f32 v68, v68
  v_exp_f32 v69, v69
  v_exp_f32 v70, v70
  v_exp_f32 v71, v71
  v_cvt_pk_bf16_f32 v82, v68, v69
  v_cvt_pk_bf16_f32 v83, v70, v71
  v_mfma_f32_32x32x8_bf16 v[48:63], v[110:111], v[92:93], v[48:63]
  v_exp_f32 v72, v72
  v_exp_f32 v73, v73
  v_exp_f32 v74, v74
  v_exp_f32 v75, v75
  v_cvt_pk_bf16_f32 v84, v72, v73
  v_cvt_pk_bf16_f32 v85, v74, v75
  v_mfma_f32_32x32x16_bf16 v[32:47], v[112:115], v[80:83], v[32:47]
  v_exp_f32 v76, v76
  v_exp_f32 v77, v77
  v_exp_f32 v78, v78
  v_exp_f32 v79, v79
  v_cvt_pk_bf16_f32 v86, v76, v77
  v_cvt_pk_bf16_f32 v87, v78, v79
  s_waitcnt lgkmcnt(0)
  v_mfma_f32_32x32x16_bf16 v[64:79], v[106:109], v[94:97], 0
  v_exp_f32 v48, v48
  v_exp_f32 v49, v49
  v_exp_f32 v50, v50
  v_exp_f32 v51, v51
  v_cvt_pk_bf16_f32 v80, v48, v49
  v_cvt_pk_bf16_f32 v81, v50, v51
  v_mfma_f32_32x32x16_bf16 v[32:47], v[120:123], v[84:87], v[32:47]
  ds_read_b128 v[100:103], v2 offset:55296
  ds_read_b64 v[104:105], v3 offset:56320
  v_exp_f32 v52, v52
  v_exp_f32 v53, v53
  v_exp_f32 v54, v54
  v_exp_f32 v55, v55
  v_cvt_pk_bf16_f32 v82, v52, v53
  v_cvt_pk_bf16_f32 v83, v54, v55
  v_mfma_f32_32x32x8_bf16 v[64:79], v[110:111], v[98:99], v[64:79]
  v_exp_f32 v56, v56
  v_exp_f32 v57, v57
  v_exp_f32 v58, v58
  v_exp_f32 v59, v59
  v_cvt_pk_bf16_f32 v84, v56, v57
  v_cvt_pk_bf16_f32 v85, v58, v59
  v_mfma_f32_32x32x16_bf16 v[16:31], v[116:119], v[80:83], v[16:31]
  v_exp_f32 v60, v60
  v_exp_f32 v61, v61
  v_exp_f32 v62, v62
  v_exp_f32 v63, v63
  v_cvt_pk_bf16_f32 v86, v60, v61
  v_cvt_pk_bf16_f32 v87, v62, v63
  s_waitcnt lgkmcnt(0)
  v_mfma_f32_32x32x16_bf16 v[48:63], v[100:103], v[88:91], 0
  v_exp_f32 v64, v64
  v_exp_f32 v65, v65
  v_exp_f32 v66, v66
  v_exp_f32 v67, v67
  v_cvt_pk_bf16_f32 v80, v64, v65
  v_cvt_pk_bf16_f32 v81, v66, v67
  v_mfma_f32_32x32x16_bf16 v[16:31], v[124:127], v[84:87], v[16:31]
  ds_read_b128 v[112:115], v4 offset:56832
  ds_read_b128 v[120:123], v4 offset:57600
  v_exp_f32 v68, v68
  v_exp_f32 v69, v69
  v_exp_f32 v70, v70
  v_exp_f32 v71, v71
  v_cvt_pk_bf16_f32 v82, v68, v69
  v_cvt_pk_bf16_f32 v83, v70, v71
  v_mfma_f32_32x32x8_bf16 v[48:63], v[104:105], v[92:93], v[48:63]
  v_exp_f32 v72, v72
  v_exp_f32 v73, v73
  v_exp_f32 v74, v74
  v_exp_f32 v75, v75
  v_cvt_pk_bf16_f32 v84, v72, v73
  v_cvt_pk_bf16_f32 v85, v74, v75
  v_mfma_f32_32x32x16_bf16 v[32:47], v[116:119], v[80:83], v[32:47]
  v_exp_f32 v76, v76
  v_exp_f32 v77, v77
  v_exp_f32 v78, v78
  v_exp_f32 v79, v79
  v_cvt_pk_bf16_f32 v86, v76, v77
  v_cvt_pk_bf16_f32 v87, v78, v79
  s_waitcnt lgkmcnt(0)
  v_mfma_f32_32x32x16_bf16 v[64:79], v[100:103], v[94:97], 0
  v_exp_f32 v48, v48
  v_exp_f32 v49, v49
  v_exp_f32 v50, v50
  v_exp_f32 v51, v51
  v_cvt_pk_bf16_f32 v80, v48, v49
  v_cvt_pk_bf16_f32 v81, v50, v51
  v_mfma_f32_32x32x16_bf16 v[32:47], v[124:127], v[84:87], v[32:47]
  ds_read_b128 v[106:109], v2 offset:58368
  ds_read_b64 v[110:111], v3 offset:59392
  v_exp_f32 v52, v52
  v_exp_f32 v53, v53
  v_exp_f32 v54, v54
  v_exp_f32 v55, v55
  v_cvt_pk_bf16_f32 v82, v52, v53
  v_cvt_pk_bf16_f32 v83, v54, v55
  v_mfma_f32_32x32x8_bf16 v[64:79], v[104:105], v[98:99], v[64:79]
  v_exp_f32 v56, v56
  v_exp_f32 v57, v57
  v_exp_f32 v58, v58
  v_exp_f32 v59, v59
  v_cvt_pk_bf16_f32 v84, v56, v57
  v_cvt_pk_bf16_f32 v85, v58, v59
  v_mfma_f32_32x32x16_bf16 v[16:31], v[112:115], v[80:83], v[16:31]
  v_exp_f32 v60, v60
  v_exp_f32 v61, v61
  v_exp_f32 v62, v62
  v_exp_f32 v63, v63
  v_cvt_pk_bf16_f32 v86, v60, v61
  v_cvt_pk_bf16_f32 v87, v62, v63
  s_waitcnt lgkmcnt(0)
  v_mfma_f32_32x32x16_bf16 v[48:63], v[106:109], v[88:91], 0
  v_exp_f32 v64, v64
  v_exp_f32 v65, v65
  v_exp_f32 v66, v66
  v_exp_f32 v67, v67
  v_cvt_pk_bf16_f32 v80, v64, v65
  v_cvt_pk_bf16_f32 v81, v66, v67
  v_mfma_f32_32x32x16_bf16 v[16:31], v[120:123], v[84:87], v[16:31]
  ds_read_b128 v[116:119], v4 offset:59904
  ds_read_b128 v[124:127], v4 offset:60672
  v_exp_f32 v68, v68
  v_exp_f32 v69, v69
  v_exp_f32 v70, v70
  v_exp_f32 v71, v71
  v_cvt_pk_bf16_f32 v82, v68, v69
  v_cvt_pk_bf16_f32 v83, v70, v71
  v_mfma_f32_32x32x8_bf16 v[48:63], v[110:111], v[92:93], v[48:63]
  v_exp_f32 v72, v72
  v_exp_f32 v73, v73
  v_exp_f32 v74, v74
  v_exp_f32 v75, v75
  v_cvt_pk_bf16_f32 v84, v72, v73
  v_cvt_pk_bf16_f32 v85, v74, v75
  v_mfma_f32_32x32x16_bf16 v[32:47], v[112:115], v[80:83], v[32:47]
  v_exp_f32 v76, v76
  v_exp_f32 v77, v77
  v_exp_f32 v78, v78
  v_exp_f32 v79, v79
  v_cvt_pk_bf16_f32 v86, v76, v77
  v_cvt_pk_bf16_f32 v87, v78, v79
  s_waitcnt vmcnt(0) lgkmcnt(0)
  s_barrier
  s_add_u32 m0, s40, 24576
  v_mfma_f32_32x32x16_bf16 v[64:79], v[106:109], v[94:97], 0
  v_exp_f32 v48, v48
  v_exp_f32 v49, v49
  v_exp_f32 v50, v50
  v_exp_f32 v51, v51
  v_cvt_pk_bf16_f32 v80, v48, v49
  v_cvt_pk_bf16_f32 v81, v50, v51
  v_mfma_f32_32x32x16_bf16 v[32:47], v[120:123], v[84:87], v[32:47]
  ds_read_b128 v[100:103], v2 offset:0
  ds_read_b64 v[104:105], v3 offset:1024
  s_cmp_ge_u32 s41, 196608
  s_cbranch_scc1 L_nodma_24
  buffer_load_dwordx4 v1, s[16:19], s41 offen offset:0 sc1 lds
L_nodma_24:
  v_exp_f32 v52, v52
  v_exp_f32 v53, v53
  v_exp_f32 v54, v54
  v_exp_f32 v55, v55
  v_cvt_pk_bf16_f32 v82, v52, v53
  v_cvt_pk_bf16_f32 v83, v54, v55
  v_mfma_f32_32x32x8_bf16 v[64:79], v[110:111], v[98:99], v[64:79]
  v_exp_f32 v56, v56
  v_exp_f32 v57, v57
  v_exp_f32 v58, v58
  v_exp_f32 v59, v59
  v_cvt_pk_bf16_f32 v84, v56, v57
  v_cvt_pk_bf16_f32 v85, v58, v59
  v_mfma_f32_32x32x16_bf16 v[16:31], v[116:119], v[80:83], v[16:31]
  v_exp_f32 v60, v60
  v_exp_f32 v61, v61
  v_exp_f32 v62, v62
  v_exp_f32 v63, v63
  v_cvt_pk_bf16_f32 v86, v60, v61
  v_cvt_pk_bf16_f32 v87, v62, v63
  s_waitcnt lgkmcnt(0)
  v_mfma_f32_32x32x16_bf16 v[48:63], v[100:103], v[88:91], 0
  v_exp_f32 v64, v64
  v_exp_f32 v65, v65
  v_exp_f32 v66, v66
  v_exp_f32 v67, v67
  v_cvt_pk_bf16_f32 v80, v64, v65
  v_cvt_pk_bf16_f32 v81, v66, v67
  v_mfma_f32_32x32x16_bf16 v[16:31], v[124:127], v[84:87], v[16:31]
  ds_read_b128 v[112:115], v4 offset:1536
  ds_read_b128 v[120:123], v4 offset:2304
  s_cmp_ge_u32 s41, 196608
  s_cbranch_scc1 L_nodma_25
  buffer_load_dwordx4 v1, s[16:19], s41 offen offset:1024 sc1 lds
  buffer_load_dwordx4 v1, s[16:19], s41 offen offset:2048 sc1 lds
L_nodma_25:
  v_exp_f32 v68, v68
  v_exp_f32 v69, v69
  v_exp_f32 v70, v70
  v_exp_f32 v71, v71
  v_cvt_pk_bf16_f32 v82, v68, v69
  v_cvt_pk_bf16_f32 v83, v70, v71
  v_mfma_f32_32x32x8_bf16 v[48:63], v[104:105], v[92:93], v[48:63]
  v_exp_f32 v72, v72
  v_exp_f32 v73, v73
  v_exp_f32 v74, v74
  v_exp_f32 v75, v75
  v_cvt_pk_bf16_f32 v84, v72, v73
  v_cvt_pk_bf16_f32 v85, v74, v75
  v_mfma_f32_32x32x16_bf16 v[32:47], v[116:119], v[80:83], v[32:47]
  v_exp_f32 v76, v76
  v_exp_f32 v77, v77
  v_exp_f32 v78, v78
  v_exp_f32 v79, v79
  v_cvt_pk_bf16_f32 v86, v76, v77
  v_cvt_pk_bf16_f32 v87, v78, v79
  s_add_u32 s41, s41, 24576
  s_waitcnt lgkmcnt(0)
  v_mfma_f32_32x32x16_bf16 v[64:79], v[100:103], v[94:97], 0
  v_exp_f32 v48, v48
  v_exp_f32 v49, v49
  v_exp_f32 v50, v50
  v_exp_f32 v51, v51
  v_cvt_pk_bf16_f32 v80, v48, v49
  v_cvt_pk_bf16_f32 v81, v50, v51
  v_mfma_f32_32x32x16_bf16 v[32:47], v[124:127], v[84:87], v[32:47]
  ds_read_b128 v[106:109], v2 offset:3072
  ds_read_b64 v[110:111], v3 offset:4096
  v_exp_f32 v52, v52
  v_exp_f32 v53, v53
  v_exp_f32 v54, v54
  v_exp_f32 v55, v55
  v_cvt_pk_bf16_f32 v82, v52, v53
  v_cvt_pk_bf16_f32 v83, v54, v55
  v_mfma_f32_32x32x8_bf16 v[64:79], v[104:105], v[98:99], v[64:79]
  v_exp_f32 v56, v56
  v_exp_f32 v57, v57
  v_exp_f32 v58, v58
  v_exp_f32 v59, v59
  v_cvt_pk_bf16_f32 v84, v56, v57
  v_cvt_pk_bf16_f32 v85, v58, v59
  v_mfma_f32_32x32x16_bf16 v[16:31], v[112:115], v[80:83], v[16:31]
  v_exp_f32 v60, v60
  v_exp_f32 v61, v61
  v_exp_f32 v62, v62
  v_exp_f32 v63, v63
  v_cvt_pk_bf16_f32 v86, v60, v61
  v_cvt_pk_bf16_f32 v87, v62, v63
  s_waitcnt lgkmcnt(0)
  v_mfma_f32_32x32x16_bf16 v[48:63], v[106:109], v[88:91], 0
  v_exp_f32 v64, v64
  v_exp_f32 v65, v65
  v_exp_f32 v66, v66
  v_exp_f32 v67, v67
  v_cvt_pk_bf16_f32 v80, v64, v65
  v_cvt_pk_bf16_f32 v81, v66, v67
  v_mfma_f32_32x32x16_bf16 v[16:31], v[120:123], v[84:87], v[16:31]
  ds_read_b128 v[116:119], v4 offset:4608
  ds_read_b128 v[124:127], v4 offset:5376
  v_exp_f32 v68, v68
  v_exp_f32 v69, v69
  v_exp_f32 v70, v70
  v_exp_f32 v71, v71
  v_cvt_pk_bf16_f32 v82, v68, v69
  v_cvt_pk_bf16_f32 v83, v70, v71
  v_mfma_f32_32x32x8_bf16 v[48:63], v[110:111], v[92:93], v[48:63]
  v_exp_f32 v72, v72
  v_exp_f32 v73, v73
  v_exp_f32 v74, v74
  v_exp_f32 v75, v75
  v_cvt_pk_bf16_f32 v84, v72, v73
  v_cvt_pk_bf16_f32 v85, v74, v75
  v_mfma_f32_32x32x16_bf16 v[32:47], v[112:115], v[80:83], v[32:47]
  v_exp_f32 v76, v76
  v_exp_f32 v77, v77
  v_exp_f32 v78, v78
  v_exp_f32 v79, v79
  v_cvt_pk_bf16_f32 v86, v76, v77
  v_cvt_pk_bf16_f32 v87, v78, v79
  s_waitcnt lgkmcnt(0)
  v_mfma_f32_32x32x16_bf16 v[64:79], v[106:109], v[94:97], 0
  v_exp_f32 v48, v48
  v_exp_f32 v49, v49
  v_exp_f32 v50, v50
  v_exp_f32 v51, v51
  v_cvt_pk_bf16_f32 v80, v48, v49
  v_cvt_pk_bf16_f32 v81, v50, v51
  v_mfma_f32_32x32x16_bf16 v[32:47], v[120:123], v[84:87], v[32:47]
  ds_read_b128 v[100:103], v2 offset:6144
  ds_read_b64 v[104:105], v3 offset:7168
  v_exp_f32 v52, v52
  v_exp_f32 v53, v53
  v_exp_f32 v54, v54
  v_exp_f32 v55, v55
  v_cvt_pk_bf16_f32 v82, v52, v53
  v_cvt_pk_bf16_f32 v83, v54, v55
  v_mfma_f32_32x32x8_bf16 v[64:79], v[110:111], v[98:99], v[64:79]
  v_exp_f32 v56, v56
  v_exp_f32 v57, v57
  v_exp_f32 v58, v58
  v_exp_f32 v59, v59
  v_cvt_pk_bf16_f32 v84, v56, v57
  v_cvt_pk_bf16_f32 v85, v58, v59
  v_mfma_f32_32x32x16_bf16 v[16:31], v[116:119], v[80:83], v[16:31]
  v_exp_f32 v60, v60
  v_exp_f32 v61, v61
  v_exp_f32 v62, v62
  v_exp_f32 v63, v63
  v_cvt_pk_bf16_f32 v86, v60, v61
  v_cvt_pk_bf16_f32 v87, v62, v63
  s_waitcnt lgkmcnt(0)
  v_mfma_f32_32x32x16_bf16 v[48:63], v[100:103], v[88:91], 0
  v_exp_f32 v64, v64
  v_exp_f32 v65, v65
  v_exp_f32 v66, v66
  v_exp_f32 v67, v67
  v_cvt_pk_bf16_f32 v80, v64, v65
  v_cvt_pk_bf16_f32 v81, v66, v67
  v_mfma_f32_32x32x16_bf16 v[16:31], v[124:127], v[84:87], v[16:31]
  ds_read_b128 v[112:115], v4 offset:7680
  ds_read_b128 v[120:123], v4 offset:8448
  v_exp_f32 v68, v68
  v_exp_f32 v69, v69
  v_exp_f32 v70, v70
  v_exp_f32 v71, v71
  v_cvt_pk_bf16_f32 v82, v68, v69
  v_cvt_pk_bf16_f32 v83, v70, v71
  v_mfma_f32_32x32x8_bf16 v[48:63], v[104:105], v[92:93], v[48:63]
  v_exp_f32 v72, v72
  v_exp_f32 v73, v73
  v_exp_f32 v74, v74
  v_exp_f32 v75, v75
  v_cvt_pk_bf16_f32 v84, v72, v73
  v_cvt_pk_bf16_f32 v85, v74, v75
  v_mfma_f32_32x32x16_bf16 v[32:47], v[116:119], v[80:83], v[32:47]
  v_exp_f32 v76, v76
  v_exp_f32 v77, v77
  v_exp_f32 v78, v78
  v_exp_f32 v79, v79
  v_cvt_pk_bf16_f32 v86, v76, v77
  v_cvt_pk_bf16_f32 v87, v78, v79
  s_waitcnt lgkmcnt(0)
  v_mfma_f32_32x32x16_bf16 v[64:79], v[100:103], v[94:97], 0
  v_exp_f32 v48, v48
  v_exp_f32 v49, v49
  v_exp_f32 v50, v50
  v_exp_f32 v51, v51
  v_cvt_pk_bf16_f32 v80, v48, v49
  v_cvt_pk_bf16_f32 v81, v50, v51
  v_mfma_f32_32x32x16_bf16 v[32:47], v[124:127], v[84:87], v[32:47]
  ds_read_b128 v[106:109], v2 offset:9216
  ds_read_b64 v[110:111], v3 offset:10240
  v_exp_f32 v52, v52
  v_exp_f32 v53, v53
  v_exp_f32 v54, v54
  v_exp_f32 v55, v55
  v_cvt_pk_bf16_f32 v82, v52, v53
  v_cvt_pk_bf16_f32 v83, v54, v55
  v_mfma_f32_32x32x8_bf16 v[64:79], v[104:105], v[98:99], v[64:79]
  v_exp_f32 v56, v56
  v_exp_f32 v57, v57
  v_exp_f32 v58, v58
  v_exp_f32 v59, v59
  v_cvt_pk_bf16_f32 v84, v56, v57
  v_cvt_pk_bf16_f32 v85, v58, v59
  v_mfma_f32_32x32x16_bf16 v[16:31], v[112:115], v[80:83], v[16:31]
  v_exp_f32 v60, v60
  v_exp_f32 v61, v61
  v_exp_f32 v62, v62
  v_exp_f32 v63, v63
  v_cvt_pk_bf16_f32 v86, v60, v61
  v_cvt_pk_bf16_f32 v87, v62, v63
  s_waitcnt lgkmcnt(0)
  v_mfma_f32_32x32x16_bf16 v[48:63], v[106:109], v[88:91], 0
  v_exp_f32 v64, v64
  v_exp_f32 v65, v65
  v_exp_f32 v66, v66
  v_exp_f32 v67, v67
  v_cvt_pk_bf16_f32 v80, v64, v65
  v_cvt_pk_bf16_f32 v81, v66, v67
  v_mfma_f32_32x32x16_bf16 v[16:31], v[120:123], v[84:87], v[16:31]
  ds_read_b128 v[116:119], v4 offset:10752
  ds_read_b128 v[124:127], v4 offset:11520
  v_exp_f32 v68, v68
  v_exp_f32 v69, v69
  v_exp_f32 v70, v70
  v_exp_f32 v71, v71
  v_cvt_pk_bf16_f32 v82, v68, v69
  v_cvt_pk_bf16_f32 v83, v70, v71
  v_mfma_f32_32x32x8_bf16 v[48:63], v[110:111], v[92:93], v[48:63]
  v_exp_f32 v72, v72
  v_exp_f32 v73, v73
  v_exp_f32 v74, v74
  v_exp_f32 v75, v75
  v_cvt_pk_bf16_f32 v84, v72, v73
  v_cvt_pk_bf16_f32 v85, v74, v75
  v_mfma_f32_32x32x16_bf16 v[32:47], v[112:115], v[80:83], v[32:47]
  v_exp_f32 v76, v76
  v_exp_f32 v77, v77
  v_exp_f32 v78, v78
  v_exp_f32 v79, v79
  v_cvt_pk_bf16_f32 v86, v76, v77
  v_cvt_pk_bf16_f32 v87, v78, v79
  s_waitcnt vmcnt(0) lgkmcnt(0)
  s_barrier
  s_add_u32 m0, s40, 49152
  v_mfma_f32_32x32x16_bf16 v[64:79], v[106:109], v[94:97], 0
  v_exp_f32 v48, v48
  v_exp_f32 v49, v49
  v_exp_f32 v50, v50
  v_exp_f32 v51, v51
  v_cvt_pk_bf16_f32 v80, v48, v49
  v_cvt_pk_bf16_f32 v81, v50, v51
  v_mfma_f32_32x32x16_bf16 v[32:47], v[120:123], v[84:87], v[32:47]
  ds_read_b128 v[100:103], v2 offset:24576
  ds_read_b64 v[104:105], v3 offset:25600
  s_cmp_ge_u32 s41, 196608
  s_cbranch_scc1 L_nodma_26
  buffer_load_dwordx4 v1, s[16:19], s41 offen offset:0 sc1 lds
L_nodma_26:
  v_exp_f32 v52, v52
  v_exp_f32 v53, v53
  v_exp_f32 v54, v54
  v_exp_f32 v55, v55
  v_cvt_pk_bf16_f32 v82, v52, v53
  v_cvt_pk_bf16_f32 v83, v54, v55
  v_mfma_f32_32x32x8_bf16 v[64:79], v[110:111], v[98:99], v[64:79]
  v_exp_f32 v56, v56
  v_exp_f32 v57, v57
  v_exp_f32 v58, v58
  v_exp_f32 v59, v59
  v_cvt_pk_bf16_f32 v84, v56, v57
  v_cvt_pk_bf16_f32 v85, v58, v59
  v_mfma_f32_32x32x16_bf16 v[16:31], v[116:119], v[80:83], v[16:31]
  v_exp_f32 v60, v60
  v_exp_f32 v61, v61
  v_exp_f32 v62, v62
  v_exp_f32 v63, v63
  v_cvt_pk_bf16_f32 v86, v60, v61
  v_cvt_pk_bf16_f32 v87, v62, v63
  s_waitcnt lgkmcnt(0)
  v_mfma_f32_32x32x16_bf16 v[48:63], v[100:103], v[88:91], 0
  v_exp_f32 v64, v64
  v_exp_f32 v65, v65
  v_exp_f32 v66, v66
  v_exp_f32 v67, v67
  v_cvt_pk_bf16_f32 v80, v64, v65
  v_cvt_pk_bf16_f32 v81, v66, v67
  v_mfma_f32_32x32x16_bf16 v[16:31], v[124:127], v[84:87], v[16:31]
  ds_read_b128 v[112:115], v4 offset:26112
  ds_read_b128 v[120:123], v4 offset:26880
  s_cmp_ge_u32 s41, 196608
  s_cbranch_scc1 L_nodma_27
  buffer_load_dwordx4 v1, s[16:19], s41 offen offset:1024 sc1 lds
  buffer_load_dwordx4 v1, s[16:19], s41 offen offset:2048 sc1 lds
L_nodma_27:
  v_exp_f32 v68, v68
  v_exp_f32 v69, v69
  v_exp_f32 v70, v70
  v_exp_f32 v71, v71
  v_cvt_pk_bf16_f32 v82, v68, v69
  v_cvt_pk_bf16_f32 v83, v70, v71
  v_mfma_f32_32x32x8_bf16 v[48:63], v[104:105], v[92:93], v[48:63]
  v_exp_f32 v72, v72
  v_exp_f32 v73, v73
  v_exp_f32 v74, v74
  v_exp_f32 v75, v75
  v_cvt_pk_bf16_f32 v84, v72, v73
  v_cvt_pk_bf16_f32 v85, v74, v75
  v_mfma_f32_32x32x16_bf16 v[32:47], v[116:119], v[80:83], v[32:47]
  v_exp_f32 v76, v76
  v_exp_f32 v77, v77
  v_exp_f32 v78, v78
  v_exp_f32 v79, v79
  v_cvt_pk_bf16_f32 v86, v76, v77
  v_cvt_pk_bf16_f32 v87, v78, v79
  s_add_u32 s41, s41, 24576
  s_cmp_ge_u32 s41, 245760
  s_cbranch_scc1 L_chunk_end_23
  s_waitcnt lgkmcnt(0)
  v_mfma_f32_32x32x16_bf16 v[64:79], v[100:103], v[94:97], 0
  v_exp_f32 v48, v48
  v_exp_f32 v49, v49
  v_exp_f32 v50, v50
  v_exp_f32 v51, v51
  v_cvt_pk_bf16_f32 v80, v48, v49
  v_cvt_pk_bf16_f32 v81, v50, v51
  v_mfma_f32_32x32x16_bf16 v[32:47], v[124:127], v[84:87], v[32:47]
  ds_read_b128 v[106:109], v2 offset:27648
  ds_read_b64 v[110:111], v3 offset:28672
  v_exp_f32 v52, v52
  v_exp_f32 v53, v53
  v_exp_f32 v54, v54
  v_exp_f32 v55, v55
  v_cvt_pk_bf16_f32 v82, v52, v53
  v_cvt_pk_bf16_f32 v83, v54, v55
  v_mfma_f32_32x32x8_bf16 v[64:79], v[104:105], v[98:99], v[64:79]
  v_exp_f32 v56, v56
  v_exp_f32 v57, v57
  v_exp_f32 v58, v58
  v_exp_f32 v59, v59
  v_cvt_pk_bf16_f32 v84, v56, v57
  v_cvt_pk_bf16_f32 v85, v58, v59
  v_mfma_f32_32x32x16_bf16 v[16:31], v[112:115], v[80:83], v[16:31]
  v_exp_f32 v60, v60
  v_exp_f32 v61, v61
  v_exp_f32 v62, v62
  v_exp_f32 v63, v63
  v_cvt_pk_bf16_f32 v86, v60, v61
  v_cvt_pk_bf16_f32 v87, v62, v63
  s_waitcnt lgkmcnt(0)
  v_mfma_f32_32x32x16_bf16 v[48:63], v[106:109], v[88:91], 0
  v_exp_f32 v64, v64
  v_exp_f32 v65, v65
  v_exp_f32 v66, v66
  v_exp_f32 v67, v67
  v_cvt_pk_bf16_f32 v80, v64, v65
  v_cvt_pk_bf16_f32 v81, v66, v67
  v_mfma_f32_32x32x16_bf16 v[16:31], v[120:123], v[84:87], v[16:31]
  ds_read_b128 v[116:119], v4 offset:29184
  ds_read_b128 v[124:127], v4 offset:29952
  v_exp_f32 v68, v68
  v_exp_f32 v69, v69
  v_exp_f32 v70, v70
  v_exp_f32 v71, v71
  v_cvt_pk_bf16_f32 v82, v68, v69
  v_cvt_pk_bf16_f32 v83, v70, v71
  v_mfma_f32_32x32x8_bf16 v[48:63], v[110:111], v[92:93], v[48:63]
  v_exp_f32 v72, v72
  v_exp_f32 v73, v73
  v_exp_f32 v74, v74
  v_exp_f32 v75, v75
  v_cvt_pk_bf16_f32 v84, v72, v73
  v_cvt_pk_bf16_f32 v85, v74, v75
  v_mfma_f32_32x32x16_bf16 v[32:47], v[112:115], v[80:83], v[32:47]
  v_exp_f32 v76, v76
  v_exp_f32 v77, v77
  v_exp_f32 v78, v78
  v_exp_f32 v79, v79
  v_cvt_pk_bf16_f32 v86, v76, v77
  v_cvt_pk_bf16_f32 v87, v78, v79
  s_waitcnt lgkmcnt(0)
  v_mfma_f32_32x32x16_bf16 v[64:79], v[106:109], v[94:97], 0
  v_exp_f32 v48, v48
  v_exp_f32 v49, v49
  v_exp_f32 v50, v50
  v_exp_f32 v51, v51
  v_cvt_pk_bf16_f32 v80, v48, v49
  v_cvt_pk_bf16_f32 v81, v50, v51
  v_mfma_f32_32x32x16_bf16 v[32:47], v[120:123], v[84:87], v[32:47]
  ds_read_b128 v[100:103], v2 offset:30720
  ds_read_b64 v[104:105], v3 offset:31744
  v_exp_f32 v52, v52
  v_exp_f32 v53, v53
  v_exp_f32 v54, v54
  v_exp_f32 v55, v55
  v_cvt_pk_bf16_f32 v82, v52, v53
  v_cvt_pk_bf16_f32 v83, v54, v55
  v_mfma_f32_32x32x8_bf16 v[64:79], v[110:111], v[98:99], v[64:79]
  v_exp_f32 v56, v56
  v_exp_f32 v57, v57
  v_exp_f32 v58, v58
  v_exp_f32 v59, v59
  v_cvt_pk_bf16_f32 v84, v56, v57
  v_cvt_pk_bf16_f32 v85, v58, v59
  v_mfma_f32_32x32x16_bf16 v[16:31], v[116:119], v[80:83], v[16:31]
  v_exp_f32 v60, v60
  v_exp_f32 v61, v61
  v_exp_f32 v62, v62
  v_exp_f32 v63, v63
  v_cvt_pk_bf16_f32 v86, v60, v61
  v_cvt_pk_bf16_f32 v87, v62, v63
  s_waitcnt lgkmcnt(0)
  v_mfma_f32_32x32x16_bf16 v[48:63], v[100:103], v[88:91], 0
  v_exp_f32 v64, v64
  v_exp_f32 v65, v65
  v_exp_f32 v66, v66
  v_exp_f32 v67, v67
  v_cvt_pk_bf16_f32 v80, v64, v65
  v_cvt_pk_bf16_f32 v81, v66, v67
  v_mfma_f32_32x32x16_bf16 v[16:31], v[124:127], v[84:87], v[16:31]
  ds_read_b128 v[112:115], v4 offset:32256
  ds_read_b128 v[120:123], v4 offset:33024
  v_exp_f32 v68, v68
  v_exp_f32 v69, v69
  v_exp_f32 v70, v70
  v_exp_f32 v71, v71
  v_cvt_pk_bf16_f32 v82, v68, v69
  v_cvt_pk_bf16_f32 v83, v70, v71
  v_mfma_f32_32x32x8_bf16 v[48:63], v[104:105], v[92:93], v[48:63]
  v_exp_f32 v72, v72
  v_exp_f32 v73, v73
  v_exp_f32 v74, v74
  v_exp_f32 v75, v75
  v_cvt_pk_bf16_f32 v84, v72, v73
  v_cvt_pk_bf16_f32 v85, v74, v75
  v_mfma_f32_32x32x16_bf16 v[32:47], v[116:119], v[80:83], v[32:47]
  v_exp_f32 v76, v76
  v_exp_f32 v77, v77
  v_exp_f32 v78, v78
  v_exp_f32 v79, v79
  v_cvt_pk_bf16_f32 v86, v76, v77
  v_cvt_pk_bf16_f32 v87, v78, v79
  s_waitcnt lgkmcnt(0)
  v_mfma_f32_32x32x16_bf16 v[64:79], v[100:103], v[94:97], 0
  v_exp_f32 v48, v48
  v_exp_f32 v49, v49
  v_exp_f32 v50, v50
  v_exp_f32 v51, v51
  v_cvt_pk_bf16_f32 v80, v48, v49
  v_cvt_pk_bf16_f32 v81, v50, v51
  v_mfma_f32_32x32x16_bf16 v[32:47], v[124:127], v[84:87], v[32:47]
  ds_read_b128 v[106:109], v2 offset:33792
  ds_read_b64 v[110:111], v3 offset:34816
  v_exp_f32 v52, v52
  v_exp_f32 v53, v53
  v_exp_f32 v54, v54
  v_exp_f32 v55, v55
  v_cvt_pk_bf16_f32 v82, v52, v53
  v_cvt_pk_bf16_f32 v83, v54, v55
  v_mfma_f32_32x32x8_bf16 v[64:79], v[104:105], v[98:99], v[64:79]
  v_exp_f32 v56, v56
  v_exp_f32 v57, v57
  v_exp_f32 v58, v58
  v_exp_f32 v59, v59
  v_cvt_pk_bf16_f32 v84, v56, v57
  v_cvt_pk_bf16_f32 v85, v58, v59
  v_mfma_f32_32x32x16_bf16 v[16:31], v[112:115], v[80:83], v[16:31]
  v_exp_f32 v60, v60
  v_exp_f32 v61, v61
  v_exp_f32 v62, v62
  v_exp_f32 v63, v63
  v_cvt_pk_bf16_f32 v86, v60, v61
  v_cvt_pk_bf16_f32 v87, v62, v63
  s_waitcnt lgkmcnt(0)
  v_mfma_f32_32x32x16_bf16 v[48:63], v[106:109], v[88:91], 0
  v_exp_f32 v64, v64
  v_exp_f32 v65, v65
  v_exp_f32 v66, v66
  v_exp_f32 v67, v67
  v_cvt_pk_bf16_f32 v80, v64, v65
  v_cvt_pk_bf16_f32 v81, v66, v67
  v_mfma_f32_32x32x16_bf16 v[16:31], v[120:123], v[84:87], v[16:31]
  ds_read_b128 v[116:119], v4 offset:35328
  ds_read_b128 v[124:127], v4 offset:36096
  v_exp_f32 v68, v68
  v_exp_f32 v69, v69
  v_exp_f32 v70, v70
  v_exp_f32 v71, v71
  v_cvt_pk_bf16_f32 v82, v68, v69
  v_cvt_pk_bf16_f32 v83, v70, v71
  v_mfma_f32_32x32x8_bf16 v[48:63], v[110:111], v[92:93], v[48:63]
  v_exp_f32 v72, v72
  v_exp_f32 v73, v73
  v_exp_f32 v74, v74
  v_exp_f32 v75, v75
  v_cvt_pk_bf16_f32 v84, v72, v73
  v_cvt_pk_bf16_f32 v85, v74, v75
  v_mfma_f32_32x32x16_bf16 v[32:47], v[112:115], v[80:83], v[32:47]
  v_exp_f32 v76, v76
  v_exp_f32 v77, v77
  v_exp_f32 v78, v78
  v_exp_f32 v79, v79
  v_cvt_pk_bf16_f32 v86, v76, v77
  v_cvt_pk_bf16_f32 v87, v78, v79
  s_waitcnt vmcnt(0) lgkmcnt(0)
  s_barrier
  s_add_u32 m0, s40, 0
  v_mfma_f32_32x32x16_bf16 v[64:79], v[106:109], v[94:97], 0
  v_exp_f32 v48, v48
  v_exp_f32 v49, v49
  v_exp_f32 v50, v50
  v_exp_f32 v51, v51
  v_cvt_pk_bf16_f32 v80, v48, v49
  v_cvt_pk_bf16_f32 v81, v50, v51
  v_mfma_f32_32x32x16_bf16 v[32:47], v[120:123], v[84:87], v[32:47]
  ds_read_b128 v[100:103], v2 offset:49152
  ds_read_b64 v[104:105], v3 offset:50176
  s_cmp_ge_u32 s41, 196608
  s_cbranch_scc1 L_nodma_28
  buffer_load_dwordx4 v1, s[16:19], s41 offen offset:0 sc1 lds
L_nodma_28:
  v_exp_f32 v52, v52
  v_exp_f32 v53, v53
  v_exp_f32 v54, v54
  v_exp_f32 v55, v55
  v_cvt_pk_bf16_f32 v82, v52, v53
  v_cvt_pk_bf16_f32 v83, v54, v55
  v_mfma_f32_32x32x8_bf16 v[64:79], v[110:111], v[98:99], v[64:79]
  v_exp_f32 v56, v56
  v_exp_f32 v57, v57
  v_exp_f32 v58, v58
  v_exp_f32 v59, v59
  v_cvt_pk_bf16_f32 v84, v56, v57
  v_cvt_pk_bf16_f32 v85, v58, v59
  v_mfma_f32_32x32x16_bf16 v[16:31], v[116:119], v[80:83], v[16:31]
  v_exp_f32 v60, v60
  v_exp_f32 v61, v61
  v_exp_f32 v62, v62
  v_exp_f32 v63, v63
  v_cvt_pk_bf16_f32 v86, v60, v61
  v_cvt_pk_bf16_f32 v87, v62, v63
  s_waitcnt lgkmcnt(0)
  v_mfma_f32_32x32x16_bf16 v[48:63], v[100:103], v[88:91], 0
  v_exp_f32 v64, v64
  v_exp_f32 v65, v65
  v_exp_f32 v66, v66
  v_exp_f32 v67, v67
  v_cvt_pk_bf16_f32 v80, v64, v65
  v_cvt_pk_bf16_f32 v81, v66, v67
  v_mfma_f32_32x32x16_bf16 v[16:31], v[124:127], v[84:87], v[16:31]
  ds_read_b128 v[112:115], v4 offset:50688
  ds_read_b128 v[120:123], v4 offset:51456
  s_cmp_ge_u32 s41, 196608
  s_cbranch_scc1 L_nodma_29
  buffer_load_dwordx4 v1, s[16:19], s41 offen offset:1024 sc1 lds
  buffer_load_dwordx4 v1, s[16:19], s41 offen offset:2048 sc1 lds
L_nodma_29:
  v_exp_f32 v68, v68
  v_exp_f32 v69, v69
  v_exp_f32 v70, v70
  v_exp_f32 v71, v71
  v_cvt_pk_bf16_f32 v82, v68, v69
  v_cvt_pk_bf16_f32 v83, v70, v71
  v_mfma_f32_32x32x8_bf16 v[48:63], v[104:105], v[92:93], v[48:63]
  v_exp_f32 v72, v72
  v_exp_f32 v73, v73
  v_exp_f32 v74, v74
  v_exp_f32 v75, v75
  v_cvt_pk_bf16_f32 v84, v72, v73
  v_cvt_pk_bf16_f32 v85, v74, v75
  v_mfma_f32_32x32x16_bf16 v[32:47], v[116:119], v[80:83], v[32:47]
  v_exp_f32 v76, v76
  v_exp_f32 v77, v77
  v_exp_f32 v78, v78
  v_exp_f32 v79, v79
  v_cvt_pk_bf16_f32 v86, v76, v77
  v_cvt_pk_bf16_f32 v87, v78, v79
  s_add_u32 s41, s41, 24576
  s_branch L_chunk3_22
L_chunk_end_23:
  s_waitcnt lgkmcnt(0)
  v_mfma_f32_32x32x16_bf16 v[32:47], v[124:127], v[84:87], v[32:47]
  s_lshl_b32 s32, s4, 10
  s_add_u32 s32, s32, 208896
  v_and_b32 v104, 31, v0
  v_lshlrev_b32 v104, 2, v104
  buffer_load_dword v105, v104, s[16:19], s32 offen sc1
  s_mul_i32 s7, s6, 3072
  s_add_u32 s7, s7, 49152
  v_lshlrev_b32 v5, 4, v0
  v_add_u32 v6, s7, v5
  s_xor_b32 s7, s6, 4
  s_mul_i32 s7, s7, 3072
  s_add_u32 s7, s7, 49152
  v_add_u32 v7, s7, v5
  s_nop 3
  s_cmp_lg_u32 s27, 0
  s_cbranch_scc1 L_cmb1_30
  ds_write_b128 v6, v[32:35] offset:0
  ds_write_b128 v6, v[36:39] offset:1024
  ds_write_b128 v6, v[40:43] offset:2048
  v_mov_b32 v48, v16
  v_mov_b32 v49, v17
  v_mov_b32 v50, v18
  v_mov_b32 v51, v19
  v_mov_b32 v52, v20
  v_mov_b32 v53, v21
  v_mov_b32 v54, v22
  v_mov_b32 v55, v23
  v_mov_b32 v56, v24
  v_mov_b32 v57, v25
  v_mov_b32 v58, v26
  v_mov_b32 v59, v27
  s_branch L_cmb2_31
L_cmb1_30:
  ds_write_b128 v6, v[16:19] offset:0
  ds_write_b128 v6, v[20:23] offset:1024
  ds_write_b128 v6, v[24:27] offset:2048
  v_mov_b32 v48, v32
  v_mov_b32 v49, v33
  v_mov_b32 v50, v34
  v_mov_b32 v51, v35
  v_mov_b32 v52, v36
  v_mov_b32 v53, v37
  v_mov_b32 v54, v38
  v_mov_b32 v55, v39
  v_mov_b32 v56, v40
  v_mov_b32 v57, v41
  v_mov_b32 v58, v42
  v_mov_b32 v59, v43
L_cmb2_31:
  s_waitcnt lgkmcnt(0)
  s_barrier
  ds_read_b128 v[64:67], v7 offset:0
  ds_read_b128 v[68:71], v7 offset:1024
  ds_read_b128 v[72:75], v7 offset:2048
  v_and_b32 v106, 31, v0
  s_lshl_b32 s7, s27, 5
  v_add_u32 v106, s7, v106
  v_mul_u32_u24 v106, 176, v106
  v_lshrrev_b32 v8, 5, v0
  v_lshl_add_u32 v106, v8, 3, v106
  s_mul_i32 s7, s26, 40
  v_add_u32 v106, s7, v106
  s_waitcnt lgkmcnt(0)
  v_add_f32 v48, v48, v64
  v_add_f32 v49, v49, v65
  v_add_f32 v50, v50, v66
  v_add_f32 v51, v51, v67
  v_add_f32 v52, v52, v68
  v_add_f32 v53, v53, v69
  v_add_f32 v54, v54, v70
  v_add_f32 v55, v55, v71
  v_add_f32 v56, v56, v72
  v_add_f32 v57, v57, v73
  v_add_f32 v58, v58, v74
  v_add_f32 v59, v59, v75
  v_mov_b32 v100, v56
  v_mov_b32 v101, v56
  s_nop 1
  v_permlane32_swap_b32 v100, v101
  s_nop 0
  v_mov_b32 v102, 0x17800000
  v_cmp_nge_f32 vcc, v101, v102
  v_rcp_f32 v101, v101
  s_lshl_b32 s32, s6, 2
  s_add_u32 s32, s32, 81408
  s_cmp_lg_u64 vcc, 0
  s_cselect_b32 s7, 1, 0
  v_mov_b32 v102, s7
  v_mov_b32 v103, s32
  ds_write_b32 v103, v102
  v_mul_f32 v48, v48, v101
  v_mul_f32 v49, v49, v101
  v_mul_f32 v50, v50, v101
  v_mul_f32 v51, v51, v101
  v_mul_f32 v52, v52, v101
  v_mul_f32 v53, v53, v101
  v_mul_f32 v54, v54, v101
  v_mul_f32 v55, v55, v101
  v_mul_f32 v56, v56, v101
  v_mul_f32 v57, v57, v101
  v_mul_f32 v58, v58, v101
  v_mul_f32 v59, v59, v101
  v_cvt_pk_bf16_f32 v64, v48, v49
  v_cvt_pk_bf16_f32 v65, v50, v51
  v_cvt_pk_bf16_f32 v66, v52, v53
  v_cvt_pk_bf16_f32 v67, v54, v55
  v_cvt_pk_bf16_f32 v68, v56, v57
  v_cvt_pk_bf16_f32 v69, v58, v59
  ds_write_b64 v106, v[64:65]
  ds_write_b64 v106, v[66:67] offset:16
  s_mov_b32 exec_hi, 0
  ds_write_b64 v106, v[68:69] offset:32
  s_mov_b32 exec_hi, -1
  s_mul_i32 s32, s6, 80
  s_mul_i32 s33, s25, 10
  v_add_u32 v100, s32, v0
  v_lshrrev_b32 v102, 6, v100
  v_and_b32 v103, 63, v100
  v_mul_u32_u24 v70, 176, v103
  v_lshl_add_u32 v70, v102, 4, v70
  v_add_u32 v70, 0, v70
  v_add_u32 v102, s33, v102
  v_lshlrev_b32 v72, 8, v102
  v_lshrrev_b32 v102, 4, v103
  v_mul_u32_u24 v102, 20480, v102
  v_add_u32 v72, v72, v102
  v_and_b32 v103, 15, v103
  v_lshl_add_u32 v72, v103, 4, v72
  v_add_u32 v100, s32, v0
  v_add_u32 v100, 64, v100
  v_lshrrev_b32 v102, 6, v100
  v_and_b32 v103, 63, v100
  v_mul_u32_u24 v71, 176, v103
  v_lshl_add_u32 v71, v102, 4, v71
  v_add_u32 v71, 0, v71
  v_add_u32 v102, s33, v102
  v_lshlrev_b32 v73, 8, v102
  v_lshrrev_b32 v102, 4, v103
  v_mul_u32_u24 v102, 20480, v102
  v_add_u32 v73, v73, v102
  v_and_b32 v103, 15, v103
  v_lshl_add_u32 v73, v103, 4, v73
  s_waitcnt lgkmcnt(0)
  s_barrier
  v_and_b32 v103, 7, v0
  v_lshlrev_b32 v103, 2, v103
  v_add_u32 v103, 81408, v103
  ds_read_b32 v102, v103
  ds_read_b128 v[74:77], v70
  ds_read_b128 v[78:81], v71
  s_waitcnt lgkmcnt(2)
  v_cmp_ne_u32 vcc, 0, v102
  s_nop 1
  s_cmp_eq_u64 vcc, 0
  s_cbranch_scc1 L_voteok_32
  s_cmp_lg_u32 s42, 0
  s_cbranch_scc1 L_voteok_32
  s_waitcnt vmcnt(0) lgkmcnt(0)
  s_mov_b32 s42, 1
  s_barrier
  s_mov_b32 exec_lo, 0
  v_mov_b32 v92, 0
  v_mov_b32 v98, 0
  s_mov_b32 exec_lo, -1
  v_mov_b32 v12, 0xff800000
  v_mov_b32 v13, 0xff800000
  s_mul_i32 s7, s27, 12288
  v_lshlrev_b32 v2, 4, v0
  v_add_u32 v2, s7, v2
  v_lshlrev_b32 v3, 3, v0
  v_add_u32 v3, s7, v3
  v_and_b32 v5, 31, v0
  v_min_u32 v5, 23, v5
  v_lshrrev_b32 v6, 5, v0
  v_mul_u32_u24 v6, 24, v6
  v_add_u32 v5, v5, v6
  v_lshlrev_b32 v4, 4, v5
  v_add_u32 v4, s7, v4
  s_mov_b32 s37, 0
L_mp_chunk_33:
  s_mul_i32 s32, s37, 24576
  s_mov_b32 s33, 0
  s_add_u32 m0, s33, s40
  s_nop 0
  buffer_load_dwordx4 v1, s[16:19], s32 offen offset:0 sc1 lds
  buffer_load_dwordx4 v1, s[16:19], s32 offen offset:1024 sc1 lds
  buffer_load_dwordx4 v1, s[16:19], s32 offen offset:2048 sc1 lds
  s_waitcnt vmcnt(0)
  s_barrier
  ds_read_b128 v[100:103], v2 offset:0
  ds_read_b64 v[104:105], v3 offset:1024
  s_waitcnt lgkmcnt(0)
  v_mfma_f32_32x32x16_bf16 v[48:63], v[100:103], v[88:91], 0
  v_mfma_f32_32x32x8_bf16 v[48:63], v[104:105], v[92:93], v[48:63]
  v_mfma_f32_32x32x16_bf16 v[64:79], v[100:103], v[94:97], 0
  v_mfma_f32_32x32x8_bf16 v[64:79], v[104:105], v[98:99], v[64:79]
  s_nop 15
  v_max3_f32 v12, v48, v49, v12
  v_max3_f32 v12, v50, v51, v12
  v_max3_f32 v12, v52, v53, v12
  v_max3_f32 v12, v54, v55, v12
  v_max3_f32 v12, v56, v57, v12
  v_max3_f32 v12, v58, v59, v12
  v_max3_f32 v12, v60, v61, v12
  v_max3_f32 v12, v62, v63, v12
  v_max3_f32 v13, v64, v65, v13
  v_max3_f32 v13, v66, v67, v13
  v_max3_f32 v13, v68, v69, v13
  v_max3_f32 v13, v70, v71, v13
  v_max3_f32 v13, v72, v73, v13
  v_max3_f32 v13, v74, v75, v13
  v_max3_f32 v13, v76, v77, v13
  v_max3_f32 v13, v78, v79, v13
  ds_read_b128 v[100:103], v2 offset:3072
  ds_read_b64 v[104:105], v3 offset:4096
  s_waitcnt lgkmcnt(0)
  v_mfma_f32_32x32x16_bf16 v[48:63], v[100:103], v[88:91], 0
  v_mfma_f32_32x32x8_bf16 v[48:63], v[104:105], v[92:93], v[48:63]
  v_mfma_f32_32x32x16_bf16 v[64:79], v[100:103], v[94:97], 0
  v_mfma_f32_32x32x8_bf16 v[64:79], v[104:105], v[98:99], v[64:79]
  s_nop 15
  v_max3_f32 v12, v48, v49, v12
  v_max3_f32 v12, v50, v51, v12
  v_max3_f32 v12, v52, v53, v12
  v_max3_f32 v12, v54, v55, v12
  v_max3_f32 v12, v56, v57, v12
  v_max3_f32 v12, v58, v59, v12
  v_max3_f32 v12, v60, v61, v12
  v_max3_f32 v12, v62, v63, v12
  v_max3_f32 v13, v64, v65, v13
  v_max3_f32 v13, v66, v67, v13
  v_max3_f32 v13, v68, v69, v13
  v_max3_f32 v13, v70, v71, v13
  v_max3_f32 v13, v72, v73, v13
  v_max3_f32 v13, v74, v75, v13
  v_max3_f32 v13, v76, v77, v13
  v_max3_f32 v13, v78, v79, v13
  ds_read_b128 v[100:103], v2 offset:6144
  ds_read_b64 v[104:105], v3 offset:7168
  s_waitcnt lgkmcnt(0)
  v_mfma_f32_32x32x16_bf16 v[48:63], v[100:103], v[88:91], 0
  v_mfma_f32_32x32x8_bf16 v[48:63], v[104:105], v[92:93], v[48:63]
  v_mfma_f32_32x32x16_bf16 v[64:79], v[100:103], v[94:97], 0
  v_mfma_f32_32x32x8_bf16 v[64:79], v[104:105], v[98:99], v[64:79]
  s_nop 15
  v_max3_f32 v12, v48, v49, v12
  v_max3_f32 v12, v50, v51, v12
  v_max3_f32 v12, v52, v53, v12
  v_max3_f32 v12, v54, v55, v12
  v_max3_f32 v12, v56, v57, v12
  v_max3_f32 v12, v58, v59, v12
  v_max3_f32 v12, v60, v61, v12
  v_max3_f32 v12, v62, v63, v12
  v_max3_f32 v13, v64, v65, v13
  v_max3_f32 v13, v66, v67, v13
  v_max3_f32 v13, v68, v69, v13
  v_max3_f32 v13, v70, v71, v13
  v_max3_f32 v13, v72, v73, v13
  v_max3_f32 v13, v74, v75, v13
  v_max3_f32 v13, v76, v77, v13
  v_max3_f32 v13, v78, v79, v13
  ds_read_b128 v[100:103], v2 offset:9216
  ds_read_b64 v[104:105], v3 offset:10240
  s_waitcnt lgkmcnt(0)
  v_mfma_f32_32x32x16_bf16 v[48:63], v[100:103], v[88:91], 0
  v_mfma_f32_32x32x8_bf16 v[48:63], v[104:105], v[92:93], v[48:63]
  v_mfma_f32_32x32x16_bf16 v[64:79], v[100:103], v[94:97], 0
  v_mfma_f32_32x32x8_bf16 v[64:79], v[104:105], v[98:99], v[64:79]
  s_nop 15
  v_max3_f32 v12, v48, v49, v12
  v_max3_f32 v12, v50, v51, v12
  v_max3_f32 v12, v52, v53, v12
  v_max3_f32 v12, v54, v55, v12
  v_max3_f32 v12, v56, v57, v12
  v_max3_f32 v12, v58, v59, v12
  v_max3_f32 v12, v60, v61, v12
  v_max3_f32 v12, v62, v63, v12
  v_max3_f32 v13, v64, v65, v13
  v_max3_f32 v13, v66, v67, v13
  v_max3_f32 v13, v68, v69, v13
  v_max3_f32 v13, v70, v71, v13
  v_max3_f32 v13, v72, v73, v13
  v_max3_f32 v13, v74, v75, v13
  v_max3_f32 v13, v76, v77, v13
  v_max3_f32 v13, v78, v79, v13
  s_barrier
  s_add_u32 s37, s37, 1
  s_cmp_lt_u32 s37, 8
  s_cbranch_scc1 L_mp_chunk_33
  v_mov_b32 v5, v12
  s_nop 1
  v_permlane32_swap_b32 v12, v5
  s_nop 0
  v_max_f32 v12, v12, v5
  v_mov_b32 v5, v13
  s_nop 1
  v_permlane32_swap_b32 v13, v5
  s_nop 0
  v_max_f32 v13, v13, v5
  s_lshl_b32 s7, s6, 9
  v_lshlrev_b32 v5, 3, v0
  v_add_u32 v6, s7, v5
  ds_write_b64 v6, v[12:13]
  s_xor_b32 s7, s6, 4
  s_lshl_b32 s7, s7, 9
  v_add_u32 v6, s7, v5
  s_waitcnt lgkmcnt(0)
  s_barrier
  ds_read_b64 v[14:15], v6
  s_waitcnt lgkmcnt(0)
  s_barrier
  v_max_f32 v12, v12, v14
  v_cvt_pk_bf16_f32 v5, v12, 0
  v_lshlrev_b32 v5, 16, v5
  v_sub_f32 v6, v12, v5
  v_cvt_pk_bf16_f32 v5, -v5, -v6
  s_mov_b32 exec_lo, 0
  v_mov_b32 v92, v5
  s_mov_b32 exec_lo, -1
  v_max_f32 v13, v13, v15
  v_cvt_pk_bf16_f32 v5, v13, 0
  v_lshlrev_b32 v5, 16, v5
  v_sub_f32 v6, v13, v5
  v_cvt_pk_bf16_f32 v5, -v5, -v6
  s_mov_b32 exec_lo, 0
  v_mov_b32 v98, v5
  s_mov_b32 exec_lo, -1
  s_branch L_attn_start_20
L_voteok_32:
  s_waitcnt vmcnt(0)
  v_cmp_ne_u32 vcc, s43, v105
  s_mul_i32 s7, s24, 81920
  s_add_u32 s7, s7, 5505024
  s_cmp_eq_u64 vcc, 0
  s_cselect_b32 s56, 1, 0
  s_waitcnt lgkmcnt(0)
  buffer_store_dwordx4 v[74:77], v72, s[16:19], s7 offen sc1
  s_mov_b64 exec, 0xffff
  buffer_store_dwordx4 v[78:81], v73, s[16:19], s7 offen sc1
  s_mov_b64 exec, -1
  s_cmp_eq_u32 s56, 0
  s_cbranch_scc1 L_fa_notready_34
  s_mul_i32 s32, s4, 327680
  s_lshl_b32 s33, s5, 7
  s_add_u32 s32, s32, s33
  s_add_u32 s32, s32, 2883584
  s_mul_i32 s33, s6, 80
  v_add_u32 v2, s33, v0
  v_lshrrev_b32 v3, 3, v2
  v_lshlrev_b32 v3, 12, v3
  v_and_b32 v4, 7, v2
  v_lshl_add_u32 v3, v4, 4, v3
  s_mul_i32 s7, s6, 1280
  s_add_u32 m0, s7, 12288
  s_nop 0
  buffer_load_dwordx4 v3, s[16:19], s32 offen sc1 lds
  v_add_u32 v2, s33, v0
  v_add_u32 v2, 64, v2
  v_lshrrev_b32 v3, 3, v2
  v_lshlrev_b32 v3, 12, v3
  v_and_b32 v4, 7, v2
  v_lshl_add_u32 v3, v4, 4, v3
  s_mul_i32 s7, s6, 1280
  s_add_u32 m0, s7, 13312
  s_mov_b64 exec, 0xffff
  buffer_load_dwordx4 v3, s[16:19], s32 offen sc1 lds
  s_mov_b64 exec, -1
  s_and_b32 s32, s6, 3
  s_lshr_b32 s33, s6, 2
  s_mul_i32 s33, s33, 5
  v_and_b32 v3, 15, v0
  s_lshl_b32 s7, s5, 2
  s_add_u32 s7, s7, s32
  s_lshl_b32 s7, s7, 4
  v_add_u32 v4, s7, v3
  s_mul_i32 s7, s4, 160
  v_lshrrev_b32 v2, 4, v0
  v_add_u32 v2, s33, v2
  v_mul_u32_u24 v5, 1280, v4
  v_lshl_add_u32 v5, v2, 4, v5
  buffer_load_dwordx4 v[8:11], v5, s[48:51], s7 offen
  v_lshlrev_b32 v6, 4, v2
  v_add_u32 v6, s7, v6
  global_load_dwordx4 v[16:19], v6, s[46:47]
  v_mul_u32_u24 v24, 2560, v4
  v_lshl_add_u32 v24, v2, 4, v24
  v_lshlrev_b32 v5, 3, v2
  v_bfe_u32 v6, v0, 2, 2
  v_add_u32 v5, v5, v6
  v_lshlrev_b32 v5, 7, v5
  v_and_b32 v6, 3, v0
  v_lshl_add_u32 v5, v6, 3, v5
  s_lshl_b32 s36, s32, 5
  s_add_u32 s36, s36, 12288
  v_add_u32 v26, s36, v5
  s_add_u32 s33, s33, 4
  v_mov_b32 v2, s33
  v_mul_u32_u24 v5, 1280, v4
  v_lshl_add_u32 v5, v2, 4, v5
  buffer_load_dwordx4 v[12:15], v5, s[48:51], s7 offen
  v_lshlrev_b32 v6, 4, v2
  v_add_u32 v6, s7, v6
  global_load_dwordx4 v[20:23], v6, s[46:47]
  v_mul_u32_u24 v25, 2560, v4
  v_lshl_add_u32 v25, v2, 4, v25
  v_lshlrev_b32 v5, 3, v2
  v_bfe_u32 v6, v0, 2, 2
  v_add_u32 v5, v5, v6
  v_lshlrev_b32 v5, 7, v5
  v_and_b32 v6, 3, v0
  v_lshl_add_u32 v5, v6, 3, v5
  s_lshl_b32 s36, s32, 5
  s_add_u32 s36, s36, 12288
  v_add_u32 v27, s36, v5
  s_waitcnt vmcnt(6)
  s_branch L_fa_w_35
L_fa_notready_34:
  s_waitcnt vmcnt(0)
L_fa_w_35:
  s_barrier
  s_cmp_lg_u32 s6, 0
  s_cbranch_scc1 L_noarr_36
  s_lshl_b32 s7, s24, 9
  s_lshl_b32 s32, s25, 2
  s_add_u32 s7, s7, s32
  s_add_u32 s7, s7, 229376
  v_mov_b32 v100, 0
  v_mov_b32 v101, s43
  s_mov_b64 exec, 0x1
  buffer_store_dword v101, v100, s[16:19], s7 offen sc1
  s_mov_b64 exec, -1
L_noarr_36:
  s_cmp_lg_u32 s56, 0
  s_cbranch_scc1 L_fa_rdy_37
  s_lshl_b32 s32, s4, 10
  s_add_u32 s32, s32, 208896
  v_add_u32 v104, s32, v104
  s_mov_b32 s36, 0
L_poll_B3_38:
  buffer_load_dword v105, v104, s[16:19], 0 offen sc1
  s_add_u32 s36, s36, 1
  s_waitcnt vmcnt(0)
  v_cmp_ne_u32 s[34:35], s43, v105
  s_nop 1
  s_and_b32 s34, s34, 0xffffffff
  s_and_b32 s35, s35, 0x0
  s_cmp_eq_u64 s[34:35], 0
  s_cbranch_scc1 L_pollout_B3_39
  s_cmp_gt_u32 s36, 20000
  s_cbranch_scc1 L_pollout_B3_39
  s_sleep 8
  s_branch L_poll_B3_38
L_pollout_B3_39:
  s_mul_i32 s32, s4, 327680
  s_lshl_b32 s33, s5, 7
  s_add_u32 s32, s32, s33
  s_add_u32 s32, s32, 2883584
  s_mul_i32 s33, s6, 80
  v_add_u32 v2, s33, v0
  v_lshrrev_b32 v3, 3, v2
  v_lshlrev_b32 v3, 12, v3
  v_and_b32 v4, 7, v2
  v_lshl_add_u32 v3, v4, 4, v3
  s_mul_i32 s7, s6, 1280
  s_add_u32 m0, s7, 12288
  s_nop 0
  buffer_load_dwordx4 v3, s[16:19], s32 offen sc1 lds
  v_add_u32 v2, s33, v0
  v_add_u32 v2, 64, v2
  v_lshrrev_b32 v3, 3, v2
  v_lshlrev_b32 v3, 12, v3
  v_and_b32 v4, 7, v2
  v_lshl_add_u32 v3, v4, 4, v3
  s_mul_i32 s7, s6, 1280
  s_add_u32 m0, s7, 13312
  s_mov_b64 exec, 0xffff
  buffer_load_dwordx4 v3, s[16:19], s32 offen sc1 lds
  s_mov_b64 exec, -1
  s_and_b32 s32, s6, 3
  s_lshr_b32 s33, s6, 2
  s_mul_i32 s33, s33, 5
  v_and_b32 v3, 15, v0
  s_lshl_b32 s7, s5, 2
  s_add_u32 s7, s7, s32
  s_lshl_b32 s7, s7, 4
  v_add_u32 v4, s7, v3
  s_mul_i32 s7, s4, 160
  v_lshrrev_b32 v2, 4, v0
  v_add_u32 v2, s33, v2
  v_mul_u32_u24 v5, 1280, v4
  v_lshl_add_u32 v5, v2, 4, v5
  buffer_load_dwordx4 v[8:11], v5, s[48:51], s7 offen
  v_lshlrev_b32 v6, 4, v2
  v_add_u32 v6, s7, v6
  global_load_dwordx4 v[16:19], v6, s[46:47]
  v_mul_u32_u24 v24, 2560, v4
  v_lshl_add_u32 v24, v2, 4, v24
  v_lshlrev_b32 v5, 3, v2
  v_bfe_u32 v6, v0, 2, 2
  v_add_u32 v5, v5, v6
  v_lshlrev_b32 v5, 7, v5
  v_and_b32 v6, 3, v0
  v_lshl_add_u32 v5, v6, 3, v5
  s_lshl_b32 s36, s32, 5
  s_add_u32 s36, s36, 12288
  v_add_u32 v26, s36, v5
  s_add_u32 s33, s33, 4
  v_mov_b32 v2, s33
  v_mul_u32_u24 v5, 1280, v4
  v_lshl_add_u32 v5, v2, 4, v5
  buffer_load_dwordx4 v[12:15], v5, s[48:51], s7 offen
  v_lshlrev_b32 v6, 4, v2
  v_add_u32 v6, s7, v6
  global_load_dwordx4 v[20:23], v6, s[46:47]
  v_mul_u32_u24 v25, 2560, v4
  v_lshl_add_u32 v25, v2, 4, v25
  v_lshlrev_b32 v5, 3, v2
  v_bfe_u32 v6, v0, 2, 2
  v_add_u32 v5, v5, v6
  v_lshlrev_b32 v5, 7, v5
  v_and_b32 v6, 3, v0
  v_lshl_add_u32 v5, v6, 3, v5
  s_lshl_b32 s36, s32, 5
  s_add_u32 s36, s36, 12288
  v_add_u32 v27, s36, v5
L_fa_rdy_37:
  s_waitcnt vmcnt(0)
  s_barrier
  ds_read_b64_tr_b16 v[28:29], v26
  ds_read_b64_tr_b16 v[30:31], v26 offset:512
  ds_read_b64_tr_b16 v[32:33], v27
  ds_read_b64_tr_b16 v[34:35], v27 offset:512
  s_mul_i32 s7, s4, 160
  s_waitcnt lgkmcnt(2)
  v_lshlrev_b32 v2, 16, v8
  v_and_b32 v3, 0xffff0000, v8
  v_lshlrev_b32 v4, 16, v16
  v_and_b32 v5, 0xffff0000, v16
  v_mul_f32 v2, v2, v4
  v_mul_f32 v3, v3, v5
  v_cvt_pk_bf16_f32 v2, v2, v3
  v_and_b32 v3, 0xffff0000, v2
  v_lshlrev_b32 v2, 16, v2
  v_lshlrev_b32 v4, 16, v28
  v_and_b32 v5, 0xffff0000, v28
  v_add_f32 v2, v2, v4
  v_add_f32 v3, v3, v5
  v_cvt_pk_bf16_f32 v40, v2, v3
  v_lshlrev_b32 v2, 16, v9
  v_and_b32 v3, 0xffff0000, v9
  v_lshlrev_b32 v4, 16, v17
  v_and_b32 v5, 0xffff0000, v17
  v_mul_f32 v2, v2, v4
  v_mul_f32 v3, v3, v5
  v_cvt_pk_bf16_f32 v2, v2, v3
  v_and_b32 v3, 0xffff0000, v2
  v_lshlrev_b32 v2, 16, v2
  v_lshlrev_b32 v4, 16, v29
  v_and_b32 v5, 0xffff0000, v29
  v_add_f32 v2, v2, v4
  v_add_f32 v3, v3, v5
  v_cvt_pk_bf16_f32 v41, v2, v3
  v_lshlrev_b32 v2, 16, v10
  v_and_b32 v3, 0xffff0000, v10
  v_lshlrev_b32 v4, 16, v18
  v_and_b32 v5, 0xffff0000, v18
  v_mul_f32 v2, v2, v4
  v_mul_f32 v3, v3, v5
  v_cvt_pk_bf16_f32 v2, v2, v3
  v_and_b32 v3, 0xffff0000, v2
  v_lshlrev_b32 v2, 16, v2
  v_lshlrev_b32 v4, 16, v30
  v_and_b32 v5, 0xffff0000, v30
  v_add_f32 v2, v2, v4
  v_add_f32 v3, v3, v5
  v_cvt_pk_bf16_f32 v42, v2, v3
  v_lshlrev_b32 v2, 16, v11
  v_and_b32 v3, 0xffff0000, v11
  v_lshlrev_b32 v4, 16, v19
  v_and_b32 v5, 0xffff0000, v19
  v_mul_f32 v2, v2, v4
  v_mul_f32 v3, v3, v5
  v_cvt_pk_bf16_f32 v2, v2, v3
  v_and_b32 v3, 0xffff0000, v2
  v_lshlrev_b32 v2, 16, v2
  v_lshlrev_b32 v4, 16, v31
  v_and_b32 v5, 0xffff0000, v31
  v_add_f32 v2, v2, v4
  v_add_f32 v3, v3, v5
  v_cvt_pk_bf16_f32 v43, v2, v3
  buffer_store_dwordx4 v[40:43], v24, s[52:55], s7 offen
  s_waitcnt lgkmcnt(0)
  v_lshlrev_b32 v2, 16, v12
  v_and_b32 v3, 0xffff0000, v12
  v_lshlrev_b32 v4, 16, v20
  v_and_b32 v5, 0xffff0000, v20
  v_mul_f32 v2, v2, v4
  v_mul_f32 v3, v3, v5
  v_cvt_pk_bf16_f32 v2, v2, v3
  v_and_b32 v3, 0xffff0000, v2
  v_lshlrev_b32 v2, 16, v2
  v_lshlrev_b32 v4, 16, v32
  v_and_b32 v5, 0xffff0000, v32
  v_add_f32 v2, v2, v4
  v_add_f32 v3, v3, v5
  v_cvt_pk_bf16_f32 v44, v2, v3
  v_lshlrev_b32 v2, 16, v13
  v_and_b32 v3, 0xffff0000, v13
  v_lshlrev_b32 v4, 16, v21
  v_and_b32 v5, 0xffff0000, v21
  v_mul_f32 v2, v2, v4
  v_mul_f32 v3, v3, v5
  v_cvt_pk_bf16_f32 v2, v2, v3
  v_and_b32 v3, 0xffff0000, v2
  v_lshlrev_b32 v2, 16, v2
  v_lshlrev_b32 v4, 16, v33
  v_and_b32 v5, 0xffff0000, v33
  v_add_f32 v2, v2, v4
  v_add_f32 v3, v3, v5
  v_cvt_pk_bf16_f32 v45, v2, v3
  v_lshlrev_b32 v2, 16, v14
  v_and_b32 v3, 0xffff0000, v14
  v_lshlrev_b32 v4, 16, v22
  v_and_b32 v5, 0xffff0000, v22
  v_mul_f32 v2, v2, v4
  v_mul_f32 v3, v3, v5
  v_cvt_pk_bf16_f32 v2, v2, v3
  v_and_b32 v3, 0xffff0000, v2
  v_lshlrev_b32 v2, 16, v2
  v_lshlrev_b32 v4, 16, v34
  v_and_b32 v5, 0xffff0000, v34
  v_add_f32 v2, v2, v4
  v_add_f32 v3, v3, v5
  v_cvt_pk_bf16_f32 v46, v2, v3
  v_lshlrev_b32 v2, 16, v15
  v_and_b32 v3, 0xffff0000, v15
  v_lshlrev_b32 v4, 16, v23
  v_and_b32 v5, 0xffff0000, v23
  v_mul_f32 v2, v2, v4
  v_mul_f32 v3, v3, v5
  v_cvt_pk_bf16_f32 v2, v2, v3
  v_and_b32 v3, 0xffff0000, v2
  v_lshlrev_b32 v2, 16, v2
  v_lshlrev_b32 v4, 16, v35
  v_and_b32 v5, 0xffff0000, v35
  v_add_f32 v2, v2, v4
  v_add_f32 v3, v3, v5
  v_cvt_pk_bf16_f32 v47, v2, v3
  s_mov_b64 exec, 0xffff
  buffer_store_dwordx4 v[44:47], v25, s[52:55], s7 offen
  s_mov_b64 exec, -1
  s_endpgm
L_exit:
  s_endpgm
.p2align 6
L_roleB:
  s_setprio 3
  s_and_b32 s3, s2, 255
  s_load_dwordx2 s[8:9], s[0:1], 0
  s_load_dwordx2 s[12:13], s[0:1], 72
  s_load_dwordx2 s[16:17], s[0:1], 128
  s_load_dwordx2 s[20:21], s[0:1], 120
  s_load_dwordx2 s[48:49], s[0:1], 104
  s_load_dwordx2 s[52:53], s[0:1], 112
  s_lshr_b32 s7, s3, 3
  s_and_b32 s7, s7, 1
  s_lshl_b32 s7, s7, 3
  s_add_u32 s7, s7, 88
  s_load_dwordx2 s[24:25], s[0:1], s7
  s_load_dwordx2 s[32:33], s[0:1], 8
  s_load_dwordx2 s[34:35], s[0:1], 16
  s_load_dwordx2 s[36:37], s[0:1], 24
  s_load_dwordx2 s[38:39], s[0:1], 32
  s_load_dwordx2 s[40:41], s[0:1], 40
  s_load_dwordx2 s[42:43], s[0:1], 48
  s_load_dwordx2 s[44:45], s[0:1], 56
  s_load_dwordx2 s[46:47], s[0:1], 64
  v_lshrrev_b32 v1, 6, v0
  s_and_b32 s4, s3, 7
  s_lshr_b32 s5, s3, 3
  v_readfirstlane_b32 s6, v1
  v_and_b32 v0, 63, v0
  s_and_b32 s84, s5, 1
  s_lshr_b32 s7, s5, 3
  s_lshl_b32 s7, s7, 3
  s_add_u32 s85, s7, s4
  s_and_b32 s86, s5, 7
  s_lshr_b32 s7, s5, 1
  s_mul_i32 s7, s7, 5
  s_mul_i32 s89, s4, 80
  s_add_u32 s89, s89, s7
  s_mov_b32 s10, 2621440
  s_mov_b32 s11, 0x20000
  s_mov_b32 s14, 2621440
  s_mov_b32 s15, 0x20000
  s_mov_b32 s18, 8683520
  s_mov_b32 s19, 0x20000
  s_mov_b32 s22, 256
  s_mov_b32 s23, 0x20000
  s_mov_b32 s26, 25600
  s_mov_b32 s27, 0x20000
  s_mov_b32 s50, 819200
  s_mov_b32 s51, 0x20000
  s_mov_b32 s54, 5242880
  s_mov_b32 s55, 0x20000
  s_lshl_b32 s93, s85, 2
  s_lshr_b32 s7, s86, 1
  s_add_u32 s93, s93, s7
  s_sub_u32 s94, s6, 3
  s_cmp_eq_u32 s6, 0
  s_cselect_b32 s94, 0, s94
  s_sub_u32 s95, s6, 1
  v_mov_b32 v2, 49120
  v_mov_b32 v4, 0
  v_mov_b32 v5, 0
  v_mov_b32 v6, 0
  v_mov_b32 v7, 0
  ds_write_b128 v2, v[4:7]
  ds_write_b128 v2, v[4:7] offset:16
  s_waitcnt lgkmcnt(0)
  s_barrier
  s_cmp_lt_u32 s95, 3
  s_cbranch_scc1 L_role_kg_42
  s_or_b32 s7, s3, s6
  s_cmp_lg_u32 s7, 0
  s_cbranch_scc1 L_nomake_43
  s_mov_b32 s56, 8650752
  s_load_dword s7, s[16:17], s56
  s_waitcnt lgkmcnt(0)
  s_mul_i32 s7, s7, 0x9e3779b1
  s_add_u32 s7, s7, 0x7f4a7c15
  s_or_b32 s7, s7, 1
  v_mov_b32 v3, s7
  v_mov_b32 v4, 0
  s_mov_b64 exec, 1
  buffer_store_dword v3, v4, s[20:23], 0 offen sc1
  s_mov_b64 exec, -1
L_nomake_43:
  v_and_b32 v2, 15, v0
  v_mul_u32_u24 v2, 1280, v2
  v_lshrrev_b32 v3, 4, v0
  v_lshl_add_u32 v2, v3, 4, v2
  s_mul_i32 s56, s93, 20480
  s_lshl_b32 s57, s94, 8
  s_add_u32 s56, s56, s57
  buffer_load_dwordx4 v[8:11], v2, s[12:15], s56 offen offset:0
  buffer_load_dwordx4 v[12:15], v2, s[12:15], s56 offen offset:64
  buffer_load_dwordx4 v[16:19], v2, s[12:15], s56 offen offset:128
  buffer_load_dwordx4 v[20:23], v2, s[12:15], s56 offen offset:192
  v_lshlrev_b32 v3, 4, v0
  s_mul_i32 s57, s94, 5120
  s_add_u32 m0, s57, 49152
  s_nop 0
  buffer_load_dwordx4 v3, s[24:27], s57 offen offset:0 lds
  buffer_load_dwordx4 v3, s[24:27], s57 offen offset:1024 lds
  buffer_load_dwordx4 v3, s[24:27], s57 offen offset:2048 lds
  buffer_load_dwordx4 v3, s[24:27], s57 offen offset:3072 lds
  s_add_u32 m0, s57, 53248
  s_add_u32 s57, s57, 4096
  buffer_load_dwordx4 v3, s[24:27], s57 offen lds
  s_setprio 3
  s_mul_i32 s57, s5, 81920
  s_mul_i32 s58, s4, 160
  s_add_u32 s57, s57, s58
  s_lshl_b32 s56, s94, 7
  v_add_u32 v2, s56, v0
  v_mul_u32_u24 v3, 6554, v2
  v_lshrrev_b32 v3, 16, v3
  v_mul_u32_u24 v3, 1120, v3
  v_lshl_add_u32 v3, v2, 4, v3
  buffer_load_dwordx4 v[104:107], v3, s[8:11], s57 offen
  v_add_u32 v2, s56, v0
  v_add_u32 v2, 64, v2
  v_mul_u32_u24 v3, 6554, v2
  v_lshrrev_b32 v3, 16, v3
  v_mul_u32_u24 v3, 1120, v3
  v_lshl_add_u32 v3, v2, 4, v3
  buffer_load_dwordx4 v[108:111], v3, s[8:11], s57 offen
  v_mov_b32 v125, 0
  buffer_load_dword v126, v125, s[20:23], 0 offen sc1
  s_setprio 3
  v_lshrrev_b32 v4, 4, v0
  v_lshlrev_b32 v4, 3, v4
  v_bfe_u32 v5, v0, 2, 2
  v_add_u32 v4, v4, v5
  v_mul_u32_u24 v4, 40, v4
  v_and_b32 v5, 3, v0
  v_lshl_add_u32 v4, v5, 3, v4
  s_mul_i32 s58, s94, 5120
  s_add_u32 s58, s58, 49152
  v_add_u32 v4, s58, v4
  s_waitcnt vmcnt(3)
  ds_read_b64_tr_b16 v[24:25], v4 offset:0
  ds_read_b64_tr_b16 v[26:27], v4 offset:160
  ds_read_b64_tr_b16 v[28:29], v4 offset:32
  ds_read_b64_tr_b16 v[30:31], v4 offset:192
  ds_read_b64_tr_b16 v[32:33], v4 offset:1280
  ds_read_b64_tr_b16 v[34:35], v4 offset:1440
  ds_read_b64_tr_b16 v[36:37], v4 offset:1312
  ds_read_b64_tr_b16 v[38:39], v4 offset:1472
  ds_read_b64_tr_b16 v[40:41], v4 offset:2560
  ds_read_b64_tr_b16 v[42:43], v4 offset:2720
  ds_read_b64_tr_b16 v[44:45], v4 offset:2592
  ds_read_b64_tr_b16 v[46:47], v4 offset:2752
  ds_read_b64_tr_b16 v[48:49], v4 offset:3840
  ds_read_b64_tr_b16 v[50:51], v4 offset:4000
  ds_read_b64_tr_b16 v[52:53], v4 offset:3872
  ds_read_b64_tr_b16 v[54:55], v4 offset:4032
  s_and_b32 s7, s86, 1
  s_cmp_lg_u32 s7, 0
  s_waitcnt lgkmcnt(0)
  s_cbranch_scc1 L_kvV_44
  v_mfma_f32_16x16x32_bf16 v[56:59], v[24:27], v[8:11], 0
  v_mfma_f32_16x16x32_bf16 v[60:63], v[28:31], v[8:11], 0
  v_mfma_f32_16x16x32_bf16 v[56:59], v[32:35], v[12:15], v[56:59]
  v_mfma_f32_16x16x32_bf16 v[60:63], v[36:39], v[12:15], v[60:63]
  v_mfma_f32_16x16x32_bf16 v[56:59], v[40:43], v[16:19], v[56:59]
  v_mfma_f32_16x16x32_bf16 v[60:63], v[44:47], v[16:19], v[60:63]
  v_mfma_f32_16x16x32_bf16 v[56:59], v[48:51], v[20:23], v[56:59]
  v_mfma_f32_16x16x32_bf16 v[60:63], v[52:55], v[20:23], v[60:63]
  s_branch L_kvW_45
L_kvV_44:
  v_mfma_f32_16x16x32_bf16 v[56:59], v[8:11], v[24:27], 0
  v_mfma_f32_16x16x32_bf16 v[60:63], v[8:11], v[28:31], 0
  v_mfma_f32_16x16x32_bf16 v[56:59], v[12:15], v[32:35], v[56:59]
  v_mfma_f32_16x16x32_bf16 v[60:63], v[12:15], v[36:39], v[60:63]
  v_mfma_f32_16x16x32_bf16 v[56:59], v[16:19], v[40:43], v[56:59]
  v_mfma_f32_16x16x32_bf16 v[60:63], v[16:19], v[44:47], v[60:63]
  v_mfma_f32_16x16x32_bf16 v[56:59], v[20:23], v[48:51], v[56:59]
  v_mfma_f32_16x16x32_bf16 v[60:63], v[20:23], v[52:55], v[60:63]
L_kvW_45:
  v_lshlrev_b32 v5, 4, v0
  v_add_u32 v6, s58, v5
  s_nop 7
  ds_write_b128 v6, v[56:59]
  ds_write_b128 v6, v[60:63] offset:1024
  s_waitcnt lgkmcnt(0)
  v_mov_b32 v6, 49124
  v_mov_b32 v7, 1
  s_mov_b64 exec, 1
  ds_add_u32 v6, v7
  s_mov_b64 exec, -1
  s_cmp_lg_u32 s6, 0
  s_cbranch_scc1 L_kv_others_46
  v_mov_b32 v6, 49124
  s_mov_b32 s82, 0
L_spin_kvp_48:
  ds_read_b32 v7, v6
  s_add_u32 s82, s82, 1
  s_waitcnt lgkmcnt(0)
  v_readfirstlane_b32 s7, v7
  s_nop 1
  s_cmp_ge_u32 s7, 5
  s_cbranch_scc1 L_spun_kvp_49
  s_cmp_gt_u32 s82, 160000
  s_cbranch_scc1 L_spun_kvp_49
  s_sleep 4
  s_branch L_spin_kvp_48
L_spun_kvp_49:
  v_add_u32 v5, 49152, v5
  ds_read_b128 v[64:67], v5 offset:0
  ds_read_b128 v[68:71], v5 offset:1024
  ds_read_b128 v[72:75], v5 offset:5120
  ds_read_b128 v[76:79], v5 offset:6144
  ds_read_b128 v[80:83], v5 offset:10240
  ds_read_b128 v[84:87], v5 offset:11264
  ds_read_b128 v[88:91], v5 offset:15360
  ds_read_b128 v[92:95], v5 offset:16384
  ds_read_b128 v[96:99], v5 offset:20480
  ds_read_b128 v[100:103], v5 offset:21504
  s_waitcnt lgkmcnt(0)
  v_mov_b32 v6, 49128
  v_mov_b32 v7, 1
  s_mov_b64 exec, 1
  ds_add_u32 v6, v7
  s_mov_b64 exec, -1
  v_add_f32 v64, v64, v72
  v_add_f32 v80, v80, v88
  v_add_f32 v64, v64, v96
  v_add_f32 v56, v64, v80
  v_add_f32 v65, v65, v73
  v_add_f32 v81, v81, v89
  v_add_f32 v65, v65, v97
  v_add_f32 v57, v65, v81
  v_add_f32 v66, v66, v74
  v_add_f32 v82, v82, v90
  v_add_f32 v66, v66, v98
  v_add_f32 v58, v66, v82
  v_add_f32 v67, v67, v75
  v_add_f32 v83, v83, v91
  v_add_f32 v67, v67, v99
  v_add_f32 v59, v67, v83
  v_add_f32 v68, v68, v76
  v_add_f32 v84, v84, v92
  v_add_f32 v68, v68, v100
  v_add_f32 v60, v68, v84
  v_add_f32 v69, v69, v77
  v_add_f32 v85, v85, v93
  v_add_f32 v69, v69, v101
  v_add_f32 v61, v69, v85
  v_add_f32 v70, v70, v78
  v_add_f32 v86, v86, v94
  v_add_f32 v70, v70, v102
  v_add_f32 v62, v70, v86
  v_add_f32 v71, v71, v79
  v_add_f32 v87, v87, v95
  v_add_f32 v71, v71, v103
  v_add_f32 v63, v71, v87
  s_lshr_b32 s56, s93, 1
  s_mul_i32 s56, s56, 3072
  s_and_b32 s57, s93, 1
  v_and_b32 v2, 15, v0
  v_lshrrev_b32 v3, 4, v0
  v_and_b32 v6, 1, v3
  v_lshrrev_b32 v7, 1, v3
  v_cvt_pk_bf16_f32 v24, v56, v57
  v_cvt_pk_bf16_f32 v25, v58, v59
  v_cvt_pk_bf16_f32 v26, v60, v61
  v_cvt_pk_bf16_f32 v27, v62, v63
  s_and_b32 s7, s86, 1
  s_cmp_lg_u32 s7, 0
  s_cbranch_scc1 L_kvVs_50
  s_lshl_b32 s7, s57, 4
  v_add_u32 v2, s7, v2
  v_lshl_add_u32 v8, v6, 5, v2
  v_lshlrev_b32 v8, 4, v8
  v_lshl_add_u32 v8, v7, 3, v8
  buffer_store_dwordx2 v[24:25], v8, s[16:19], s56 offen sc1
  v_mul_f32 v9, v56, v56
  v_fmac_f32 v9, v57, v57
  v_fmac_f32 v9, v58, v58
  v_fmac_f32 v9, v59, v59
  s_mov_b64 exec, 0xffff
  v_fmac_f32 v9, v60, v60
  v_fmac_f32 v9, v61, v61
  v_fmac_f32 v9, v62, v62
  v_fmac_f32 v9, v63, v63
  s_mov_b64 exec, -1
  s_mov_b32 exec_lo, 0xffff0000
  s_mov_b32 exec_hi, 0
  v_mov_b32 v26, 0x3f803f80
  v_mov_b32 v27, 0
  s_mov_b64 exec, -1
  v_lshl_add_u32 v8, v3, 5, v2
  v_lshlrev_b32 v8, 3, v8
  s_mov_b32 exec_hi, 0
  buffer_store_dwordx2 v[26:27], v8, s[16:19], s56 offen offset:1024 sc1
  s_mov_b32 exec_hi, -1
  v_mov_b32 v10, v9
  s_nop 1
  v_permlane32_swap_b32 v9, v10
  s_nop 0
  v_add_f32 v9, v9, v10
  v_mov_b32 v10, v9
  s_nop 1
  v_permlane16_swap_b32 v9, v10
  s_nop 0
  v_add_f32 v9, v9, v10
  s_nop 1
  v_max_f32_dpp v9, v9, v9 row_shr:1 row_mask:0xf bank_mask:0xf
  s_nop 1
  v_max_f32_dpp v9, v9, v9 row_shr:2 row_mask:0xf bank_mask:0xf
  s_nop 1
  v_max_f32_dpp v9, v9, v9 row_shr:4 row_mask:0xf bank_mask:0xf
  s_nop 1
  v_max_f32_dpp v9, v9, v9 row_shr:8 row_mask:0xf bank_mask:0xf
  s_nop 1
  v_readlane_b32 s7, v9, 15
  s_lshl_b32 s57, s93, 2
  s_add_u32 s57, s57, 227328
  v_mov_b32 v10, 0
  v_mov_b32 v9, s7
  s_mov_b64 exec, 1
  buffer_store_dword v9, v10, s[16:19], s57 offen sc1
  s_mov_b64 exec, -1
  s_branch L_kv_flag_51
L_kvVs_50:
  s_mul_i32 s7, s57, 768
  s_add_u32 s56, s56, s7
  v_mul_u32_u24 v8, 24, v6
  v_add_u32 v8, v8, v2
  v_lshlrev_b32 v8, 4, v8
  v_lshl_add_u32 v8, v7, 3, v8
  buffer_store_dwordx2 v[24:25], v8, s[16:19], s56 offen offset:1536 sc1
  s_mov_b32 exec_lo, 0xfff0fff0
  s_mov_b32 exec_hi, 0xfff0fff0
  v_mov_b32 v26, 0
  v_mov_b32 v27, 0
  s_mov_b32 exec_lo, 0x00100010
  s_mov_b32 exec_hi, 0x00100010
  v_mov_b32 v26, 0x3f803f80
  v_mov_b32 v27, 0x3f803f80
  s_mov_b32 exec_lo, 0x00ff00ff
  s_mov_b32 exec_hi, 0x00ff00ff
  buffer_store_dwordx2 v[26:27], v8, s[16:19], s56 offen offset:1792 sc1
  s_mov_b64 exec, -1
L_kv_flag_51:
  s_waitcnt vmcnt(0)
  s_mov_b32 s82, 0
L_nonce_52:
  v_readfirstlane_b32 s92, v126
  s_nop 1
  s_cmp_lg_u32 s92, 0
  s_cbranch_scc1 L_nonce_ok_53
  s_add_u32 s82, s82, 1
  s_cmp_gt_u32 s82, 20000
  s_cbranch_scc1 L_nonce_ok_53
  s_sleep 4
  v_mov_b32 v125, 0
  buffer_load_dword v126, v125, s[20:23], 0 offen sc1
  s_waitcnt vmcnt(0)
  s_branch L_nonce_52
L_nonce_ok_53:
  s_lshl_b32 s56, s85, 3
  s_add_u32 s56, s56, s86
  s_lshl_b32 s56, s56, 2
  s_add_u32 s56, s56, 8650752
  v_mul_u32_u24 v6, 1024, v0
  v_mov_b32 v7, s92
  s_mov_b64 exec, 0xff
  buffer_store_dword v7, v6, s[16:19], s56 offen sc1
  s_mov_b64 exec, -1
  s_branch L_kv_done_47
L_kv_others_46:
  v_mov_b32 v6, 49128
  s_mov_b32 s82, 0
L_spin_kvf_54:
  ds_read_b32 v7, v6
  s_add_u32 s82, s82, 1
  s_waitcnt lgkmcnt(0)
  v_readfirstlane_b32 s7, v7
  s_nop 1
  s_cmp_ge_u32 s7, 1
  s_cbranch_scc1 L_spun_kvf_55
  s_cmp_gt_u32 s82, 160000
  s_cbranch_scc1 L_spun_kvf_55
  s_sleep 4
  s_branch L_spin_kvf_54
L_spun_kvf_55:
L_kv_done_47:
  s_setprio 3
  s_waitcnt vmcnt(0)
  s_mov_b32 s82, 0
L_nonce_56:
  v_readfirstlane_b32 s92, v126
  s_nop 1
  s_cmp_lg_u32 s92, 0
  s_cbranch_scc1 L_nonce_ok_57
  s_add_u32 s82, s82, 1
  s_cmp_gt_u32 s82, 20000
  s_cbranch_scc1 L_nonce_ok_57
  s_sleep 4
  v_mov_b32 v125, 0
  buffer_load_dword v126, v125, s[20:23], 0 offen sc1
  s_waitcnt vmcnt(0)
  s_branch L_nonce_56
L_nonce_ok_57:
  s_lshl_b32 s7, s94, 11
  s_add_u32 s7, s7, 71680
  v_lshlrev_b32 v2, 4, v0
  v_add_u32 v2, s7, v2
  ds_write_b128 v2, v[104:107]
  ds_write_b128 v2, v[108:111] offset:1024
  s_waitcnt lgkmcnt(0)
  v_mov_b32 v2, 49132
  v_mov_b32 v3, 1
  s_mov_b64 exec, 1
  ds_add_u32 v2, v3
  s_mov_b64 exec, -1
  v_mov_b32 v2, 49132
  s_mov_b32 s82, 0
L_spin_ut_58:
  ds_read_b32 v3, v2
  s_add_u32 s82, s82, 1
  s_waitcnt lgkmcnt(0)
  v_readfirstlane_b32 s7, v3
  s_nop 1
  s_cmp_ge_u32 s7, 5
  s_cbranch_scc1 L_spun_ut_59
  s_cmp_gt_u32 s82, 160000
  s_cbranch_scc1 L_spun_ut_59
  s_sleep 4
  s_branch L_spin_ut_58
L_spun_ut_59:
  s_sub_u32 s56, s6, 4
  s_cmp_eq_u32 s6, 0
  s_cselect_b32 s56, 4, s56
  v_lshrrev_b32 v2, 4, v0
  v_lshlrev_b32 v2, 3, v2
  v_bfe_u32 v3, v0, 2, 2
  v_add_u32 v2, v2, v3
  v_mul_u32_u24 v2, 160, v2
  v_and_b32 v3, 3, v0
  v_lshl_add_u32 v2, v3, 3, v2
  s_lshl_b32 s7, s56, 5
  s_add_u32 s7, s7, 71680
  v_add_u32 v2, s7, v2
  v_and_b32 v3, 15, v0
  v_lshlrev_b32 v3, 12, v3
  v_lshrrev_b32 v4, 4, v0
  v_lshl_add_u32 v3, v4, 4, v3
  s_mul_i32 s7, s4, 80
  s_lshl_b32 s56, s56, 4
  s_add_u32 s7, s7, s56
  s_lshl_b32 s7, s7, 12
  s_lshl_b32 s56, s5, 7
  s_add_u32 s7, s7, s56
  s_add_u32 s7, s7, 262144
  ds_read_b64_tr_b16 v[8:9], v2 offset:0
  ds_read_b64_tr_b16 v[10:11], v2 offset:640
  ds_read_b64_tr_b16 v[12:13], v2 offset:5120
  ds_read_b64_tr_b16 v[14:15], v2 offset:5760
  s_waitcnt lgkmcnt(2)
  buffer_store_dwordx4 v[8:11], v3, s[16:19], s7 offen sc1
  s_waitcnt lgkmcnt(0)
  buffer_store_dwordx4 v[12:15], v3, s[16:19], s7 offen offset:64 sc1
  s_waitcnt vmcnt(0)
  s_lshl_b32 s56, s4, 10
  s_lshl_b32 s7, s5, 2
  s_add_u32 s56, s56, s7
  s_add_u32 s56, s56, 200704
  v_mov_b32 v2, 49120
  v_mov_b32 v3, 1
  s_mov_b64 exec, 1
  ds_add_rtn_u32 v3, v2, v3
  s_waitcnt lgkmcnt(0)
  v_readfirstlane_b32 s7, v3
  s_mov_b64 exec, -1
  s_nop 1
  s_cmp_lg_u32 s7, 4
  s_cbranch_scc1 L_arr_b0_60
  v_mov_b32 v2, 0
  v_mov_b32 v3, s92
  s_mov_b64 exec, 0x1
  buffer_store_dword v3, v2, s[16:19], s56 offen sc1
  s_mov_b64 exec, -1
L_arr_b0_60:
  s_branch L_role_join_41
L_role_kg_42:
  s_setprio 3
  s_sub_u32 s95, s6, 1
  s_cmp_ge_u32 s95, 3
  s_cbranch_scc1 L_kgl_skip_61
  s_cmp_eq_u32 s95, 2
  s_cbranch_scc1 L_cs_62
  s_mul_i32 s83, s84, 3
  s_add_u32 s83, s83, s89
  s_add_u32 s83, s83, s95
  s_branch L_cs_63
L_cs_62:
  s_add_u32 s83, s89, 2
L_cs_63:
  s_lshl_b32 s7, s83, 8
  v_lshlrev_b32 v2, 1, v0
  v_add_u32 v2, s7, v2
  global_load_ushort v112, v2, s[32:33] offset:0
  global_load_ushort v113, v2, s[34:35] offset:0
  global_load_ushort v114, v2, s[36:37] offset:0
  global_load_ushort v115, v2, s[38:39] offset:0
  global_load_ushort v116, v2, s[40:41] offset:0
  global_load_ushort v117, v2, s[42:43] offset:0
  global_load_ushort v118, v2, s[32:33] offset:128
  global_load_ushort v119, v2, s[34:35] offset:128
  global_load_ushort v120, v2, s[36:37] offset:128
  global_load_ushort v121, v2, s[38:39] offset:128
  global_load_ushort v122, v2, s[40:41] offset:128
  global_load_ushort v123, v2, s[42:43] offset:128
  s_lshl_b32 s7, s83, 1
  v_mov_b32 v3, s7
  global_load_ushort v124, v3, s[44:45]
L_kgl_skip_61:
  v_mov_b32 v125, 0
  buffer_load_dword v126, v125, s[20:23], 0 offen sc1
  s_setprio 3
  s_waitcnt vmcnt(1)
  s_mul_i32 s56, s95, 16384
  v_lshlrev_b32 v4, 2, v0
  v_add_u32 v4, s56, v4
  v_and_b32 v5, 31, v0
  v_mul_u32_u24 v21, 272, v5
  v_subrev_u32 v6, 3, v5
  v_cmp_lt_u32 vcc, 27, v5
  s_nop 1
  v_cndmask_b32 v5, v5, v6, vcc
  v_mul_u32_u24 v5, 272, v5
  v_lshrrev_b32 v6, 5, v0
  v_lshl_add_u32 v5, v6, 4, v5
  v_add_u32 v5, s56, v5
  v_lshl_add_u32 v21, v6, 4, v21
  v_add_u32 v21, s56, v21
  v_lshlrev_b32 v20, 16, v124
  s_mov_b32 s7, 0x3fb8aa3b
  v_mul_f32 v20, s7, v20
  v_exp_f32 v20, v20
  s_nop 0
  v_cvt_pk_bf16_f32 v20, v20, v20
  v_lshlrev_b32 v20, 16, v20
  v_lshlrev_b32 v112, 16, v112
  v_lshlrev_b32 v113, 16, v113
  v_lshlrev_b32 v114, 16, v114
  v_lshlrev_b32 v115, 16, v115
  v_lshlrev_b32 v116, 16, v116
  v_lshlrev_b32 v117, 16, v117
  v_mul_f32 v22, v20, v112
  v_mul_f32 v23, v20, v113
  s_mov_b32 s7, 0x3fb8aa3b
  v_mul_f32 v22, s7, v22
  v_mul_f32 v23, 0x3e22f983, v23
  v_mul_f32 v114, v20, v114
  v_mul_f32 v115, v20, v115
  v_mul_f32 v38, v117, v115
  v_fma_f32 v34, v116, v114, -v38
  v_mul_f32 v38, v117, v114
  v_fma_f32 v35, v116, v115, v38
  v_exp_f32 v38, v22
  v_fract_f32 v39, v23
  v_cos_f32 v24, v39
  v_sin_f32 v25, v39
  s_nop 0
  v_mul_f32 v24, v24, v38
  v_mul_f32 v25, v25, v38
  v_mul_f32 v38, 0x43800000, v22
  v_mul_f32 v39, 0x43800000, v23
  v_exp_f32 v38, v38
  v_fract_f32 v39, v39
  v_cos_f32 v32, v39
  v_sin_f32 v33, v39
  s_nop 0
  v_mul_f32 v32, v32, v38
  v_mul_f32 v33, v33, v38
  v_pk_mul_f32 v[38:39], v[24:25], v[24:25] op_sel:[1,1] op_sel_hi:[1,0]
  v_pk_fma_f32 v[26:27], v[24:25], v[24:25], v[38:39] op_sel:[0,0,0] op_sel_hi:[0,1,1] neg_lo:[0,0,1]
  v_pk_mul_f32 v[38:39], v[26:27], v[26:27] op_sel:[1,1] op_sel_hi:[1,0]
  v_pk_fma_f32 v[28:29], v[26:27], v[26:27], v[38:39] op_sel:[0,0,0] op_sel_hi:[0,1,1] neg_lo:[0,0,1]
  v_pk_mul_f32 v[38:39], v[28:29], v[28:29] op_sel:[1,1] op_sel_hi:[1,0]
  v_pk_fma_f32 v[30:31], v[28:29], v[28:29], v[38:39] op_sel:[0,0,0] op_sel_hi:[0,1,1] neg_lo:[0,0,1]
  v_mov_b32 v42, v30
  v_xor_b32 v43, 0x80000000, v31
  v_cvt_pk_bf16_f32 v44, v34, v35
  v_mov_b32 v40, 1.0
  ds_write_b32 v4, v44 offset:0
  v_mov_b32 v41, 0
  v_cvt_pk_bf16_f32 v45, v40, v41
  ds_write_b32 v4, v45 offset:7344
  v_pk_mul_f32 v[38:39], v[34:35], v[24:25] op_sel:[1,1] op_sel_hi:[1,0]
  v_pk_mul_f32 v[50:51], v[40:41], v[42:43] op_sel:[1,1] op_sel_hi:[1,0]
  v_pk_fma_f32 v[36:37], v[34:35], v[24:25], v[38:39] op_sel:[0,0,0] op_sel_hi:[0,1,1] neg_lo:[0,0,1]
  v_pk_fma_f32 v[40:41], v[40:41], v[42:43], v[50:51] op_sel:[0,0,0] op_sel_hi:[0,1,1] neg_lo:[0,0,1]
  v_cvt_pk_bf16_f32 v44, v36, v37
  v_cvt_pk_bf16_f32 v45, v40, v41
  ds_write_b32 v4, v44 offset:272
  ds_write_b32 v4, v45 offset:7616
  v_pk_mul_f32 v[38:39], v[36:37], v[24:25] op_sel:[1,1] op_sel_hi:[1,0]
  v_pk_mul_f32 v[50:51], v[40:41], v[42:43] op_sel:[1,1] op_sel_hi:[1,0]
  v_pk_fma_f32 v[36:37], v[36:37], v[24:25], v[38:39] op_sel:[0,0,0] op_sel_hi:[0,1,1] neg_lo:[0,0,1]
  v_pk_fma_f32 v[40:41], v[40:41], v[42:43], v[50:51] op_sel:[0,0,0] op_sel_hi:[0,1,1] neg_lo:[0,0,1]
  v_cvt_pk_bf16_f32 v44, v36, v37
  v_cvt_pk_bf16_f32 v45, v40, v41
  ds_write_b32 v4, v44 offset:544
  ds_write_b32 v4, v45 offset:7888
  v_pk_mul_f32 v[38:39], v[36:37], v[24:25] op_sel:[1,1] op_sel_hi:[1,0]
  v_pk_mul_f32 v[50:51], v[40:41], v[42:43] op_sel:[1,1] op_sel_hi:[1,0]
  v_pk_fma_f32 v[36:37], v[36:37], v[24:25], v[38:39] op_sel:[0,0,0] op_sel_hi:[0,1,1] neg_lo:[0,0,1]
  v_pk_fma_f32 v[40:41], v[40:41], v[42:43], v[50:51] op_sel:[0,0,0] op_sel_hi:[0,1,1] neg_lo:[0,0,1]
  v_cvt_pk_bf16_f32 v44, v36, v37
  v_cvt_pk_bf16_f32 v45, v40, v41
  ds_write_b32 v4, v44 offset:816
  ds_write_b32 v4, v45 offset:8160
  v_pk_mul_f32 v[38:39], v[36:37], v[24:25] op_sel:[1,1] op_sel_hi:[1,0]
  v_pk_mul_f32 v[50:51], v[40:41], v[42:43] op_sel:[1,1] op_sel_hi:[1,0]
  v_pk_fma_f32 v[36:37], v[36:37], v[24:25], v[38:39] op_sel:[0,0,0] op_sel_hi:[0,1,1] neg_lo:[0,0,1]
  v_pk_fma_f32 v[40:41], v[40:41], v[42:43], v[50:51] op_sel:[0,0,0] op_sel_hi:[0,1,1] neg_lo:[0,0,1]
  v_cvt_pk_bf16_f32 v44, v36, v37
  v_cvt_pk_bf16_f32 v45, v40, v41
  ds_write_b32 v4, v44 offset:2176
  ds_write_b32 v4, v45 offset:8432
  v_pk_mul_f32 v[38:39], v[36:37], v[24:25] op_sel:[1,1] op_sel_hi:[1,0]
  v_pk_mul_f32 v[50:51], v[40:41], v[42:43] op_sel:[1,1] op_sel_hi:[1,0]
  v_pk_fma_f32 v[36:37], v[36:37], v[24:25], v[38:39] op_sel:[0,0,0] op_sel_hi:[0,1,1] neg_lo:[0,0,1]
  v_pk_fma_f32 v[40:41], v[40:41], v[42:43], v[50:51] op_sel:[0,0,0] op_sel_hi:[0,1,1] neg_lo:[0,0,1]
  v_cvt_pk_bf16_f32 v44, v36, v37
  v_cvt_pk_bf16_f32 v45, v40, v41
  ds_write_b32 v4, v44 offset:2448
  ds_write_b32 v4, v45 offset:8704
  v_pk_mul_f32 v[38:39], v[36:37], v[24:25] op_sel:[1,1] op_sel_hi:[1,0]
  v_pk_mul_f32 v[50:51], v[40:41], v[42:43] op_sel:[1,1] op_sel_hi:[1,0]
  v_pk_fma_f32 v[36:37], v[36:37], v[24:25], v[38:39] op_sel:[0,0,0] op_sel_hi:[0,1,1] neg_lo:[0,0,1]
  v_pk_fma_f32 v[40:41], v[40:41], v[42:43], v[50:51] op_sel:[0,0,0] op_sel_hi:[0,1,1] neg_lo:[0,0,1]
  v_cvt_pk_bf16_f32 v44, v36, v37
  v_cvt_pk_bf16_f32 v45, v40, v41
  ds_write_b32 v4, v44 offset:2720
  ds_write_b32 v4, v45 offset:8976
  v_pk_mul_f32 v[38:39], v[36:37], v[24:25] op_sel:[1,1] op_sel_hi:[1,0]
  v_pk_mul_f32 v[50:51], v[40:41], v[42:43] op_sel:[1,1] op_sel_hi:[1,0]
  v_pk_fma_f32 v[36:37], v[36:37], v[24:25], v[38:39] op_sel:[0,0,0] op_sel_hi:[0,1,1] neg_lo:[0,0,1]
  v_pk_fma_f32 v[40:41], v[40:41], v[42:43], v[50:51] op_sel:[0,0,0] op_sel_hi:[0,1,1] neg_lo:[0,0,1]
  v_cvt_pk_bf16_f32 v44, v36, v37
  v_cvt_pk_bf16_f32 v45, v40, v41
  ds_write_b32 v4, v44 offset:2992
  ds_write_b32 v4, v45 offset:9248
  v_pk_mul_f32 v[38:39], v[34:35], v[32:33] op_sel:[1,1] op_sel_hi:[1,0]
  v_pk_mul_f32 v[50:51], v[40:41], v[42:43] op_sel:[1,1] op_sel_hi:[1,0]
  v_pk_fma_f32 v[46:47], v[34:35], v[32:33], v[38:39] op_sel:[0,0,0] op_sel_hi:[0,1,1] neg_lo:[0,0,1]
  v_pk_fma_f32 v[40:41], v[40:41], v[42:43], v[50:51] op_sel:[0,0,0] op_sel_hi:[0,1,1] neg_lo:[0,0,1]
  v_cvt_pk_bf16_f32 v44, v46, v47
  v_cvt_pk_bf16_f32 v45, v40, v41
  ds_write_b32 v4, v44 offset:4352
  ds_write_b32 v4, v45 offset:9520
  v_pk_mul_f32 v[38:39], v[46:47], v[26:27] op_sel:[1,1] op_sel_hi:[1,0]
  v_pk_mul_f32 v[50:51], v[40:41], v[42:43] op_sel:[1,1] op_sel_hi:[1,0]
  v_pk_fma_f32 v[36:37], v[46:47], v[26:27], v[38:39] op_sel:[0,0,0] op_sel_hi:[0,1,1] neg_lo:[0,0,1]
  v_pk_fma_f32 v[40:41], v[40:41], v[42:43], v[50:51] op_sel:[0,0,0] op_sel_hi:[0,1,1] neg_lo:[0,0,1]
  v_cvt_pk_bf16_f32 v44, v36, v37
  v_cvt_pk_bf16_f32 v45, v40, v41
  ds_write_b32 v4, v44 offset:4624
  ds_write_b32 v4, v45 offset:9792
  v_pk_mul_f32 v[38:39], v[36:37], v[26:27] op_sel:[1,1] op_sel_hi:[1,0]
  v_pk_mul_f32 v[50:51], v[40:41], v[42:43] op_sel:[1,1] op_sel_hi:[1,0]
  v_pk_fma_f32 v[36:37], v[36:37], v[26:27], v[38:39] op_sel:[0,0,0] op_sel_hi:[0,1,1] neg_lo:[0,0,1]
  v_pk_fma_f32 v[40:41], v[40:41], v[42:43], v[50:51] op_sel:[0,0,0] op_sel_hi:[0,1,1] neg_lo:[0,0,1]
  v_cvt_pk_bf16_f32 v44, v36, v37
  v_cvt_pk_bf16_f32 v45, v40, v41
  ds_write_b32 v4, v44 offset:4896
  ds_write_b32 v4, v45 offset:10064
  v_pk_mul_f32 v[38:39], v[36:37], v[26:27] op_sel:[1,1] op_sel_hi:[1,0]
  v_pk_mul_f32 v[50:51], v[40:41], v[42:43] op_sel:[1,1] op_sel_hi:[1,0]
  v_pk_fma_f32 v[36:37], v[36:37], v[26:27], v[38:39] op_sel:[0,0,0] op_sel_hi:[0,1,1] neg_lo:[0,0,1]
  v_pk_fma_f32 v[40:41], v[40:41], v[42:43], v[50:51] op_sel:[0,0,0] op_sel_hi:[0,1,1] neg_lo:[0,0,1]
  v_cvt_pk_bf16_f32 v44, v36, v37
  v_cvt_pk_bf16_f32 v45, v40, v41
  ds_write_b32 v4, v44 offset:5168
  ds_write_b32 v4, v45 offset:10336
  v_pk_mul_f32 v[38:39], v[36:37], v[26:27] op_sel:[1,1] op_sel_hi:[1,0]
  v_pk_mul_f32 v[50:51], v[40:41], v[42:43] op_sel:[1,1] op_sel_hi:[1,0]
  v_pk_fma_f32 v[36:37], v[36:37], v[26:27], v[38:39] op_sel:[0,0,0] op_sel_hi:[0,1,1] neg_lo:[0,0,1]
  v_pk_fma_f32 v[40:41], v[40:41], v[42:43], v[50:51] op_sel:[0,0,0] op_sel_hi:[0,1,1] neg_lo:[0,0,1]
  v_cvt_pk_bf16_f32 v44, v36, v37
  v_cvt_pk_bf16_f32 v45, v40, v41
  ds_write_b32 v4, v44 offset:6528
  ds_write_b32 v4, v45 offset:10608
  v_pk_mul_f32 v[38:39], v[46:47], v[32:33] op_sel:[1,1] op_sel_hi:[1,0]
  v_pk_mul_f32 v[50:51], v[40:41], v[42:43] op_sel:[1,1] op_sel_hi:[1,0]
  v_pk_fma_f32 v[46:47], v[46:47], v[32:33], v[38:39] op_sel:[0,0,0] op_sel_hi:[0,1,1] neg_lo:[0,0,1]
  v_pk_fma_f32 v[40:41], v[40:41], v[42:43], v[50:51] op_sel:[0,0,0] op_sel_hi:[0,1,1] neg_lo:[0,0,1]
  v_cvt_pk_bf16_f32 v44, v46, v47
  v_cvt_pk_bf16_f32 v45, v40, v41
  ds_write_b32 v4, v44 offset:1088
  ds_write_b32 v4, v45 offset:10880
  v_pk_mul_f32 v[38:39], v[46:47], v[28:29] op_sel:[1,1] op_sel_hi:[1,0]
  v_pk_mul_f32 v[50:51], v[40:41], v[42:43] op_sel:[1,1] op_sel_hi:[1,0]
  v_pk_fma_f32 v[36:37], v[46:47], v[28:29], v[38:39] op_sel:[0,0,0] op_sel_hi:[0,1,1] neg_lo:[0,0,1]
  v_pk_fma_f32 v[40:41], v[40:41], v[42:43], v[50:51] op_sel:[0,0,0] op_sel_hi:[0,1,1] neg_lo:[0,0,1]
  v_cvt_pk_bf16_f32 v44, v36, v37
  v_cvt_pk_bf16_f32 v45, v40, v41
  ds_write_b32 v4, v44 offset:1360
  ds_write_b32 v4, v45 offset:11152
  v_pk_mul_f32 v[38:39], v[36:37], v[28:29] op_sel:[1,1] op_sel_hi:[1,0]
  v_pk_mul_f32 v[50:51], v[40:41], v[42:43] op_sel:[1,1] op_sel_hi:[1,0]
  v_pk_fma_f32 v[36:37], v[36:37], v[28:29], v[38:39] op_sel:[0,0,0] op_sel_hi:[0,1,1] neg_lo:[0,0,1]
  v_pk_fma_f32 v[40:41], v[40:41], v[42:43], v[50:51] op_sel:[0,0,0] op_sel_hi:[0,1,1] neg_lo:[0,0,1]
  v_cvt_pk_bf16_f32 v44, v36, v37
  v_cvt_pk_bf16_f32 v45, v40, v41
  ds_write_b32 v4, v44 offset:1632
  ds_write_b32 v4, v45 offset:11424
  v_pk_mul_f32 v[38:39], v[46:47], v[32:33] op_sel:[1,1] op_sel_hi:[1,0]
  v_pk_mul_f32 v[50:51], v[40:41], v[42:43] op_sel:[1,1] op_sel_hi:[1,0]
  v_pk_fma_f32 v[46:47], v[46:47], v[32:33], v[38:39] op_sel:[0,0,0] op_sel_hi:[0,1,1] neg_lo:[0,0,1]
  v_pk_fma_f32 v[40:41], v[40:41], v[42:43], v[50:51] op_sel:[0,0,0] op_sel_hi:[0,1,1] neg_lo:[0,0,1]
  v_cvt_pk_bf16_f32 v44, v46, v47
  v_cvt_pk_bf16_f32 v45, v40, v41
  ds_write_b32 v4, v44 offset:1904
  ds_write_b32 v4, v45 offset:11696
  v_pk_mul_f32 v[38:39], v[46:47], v[28:29] op_sel:[1,1] op_sel_hi:[1,0]
  v_pk_mul_f32 v[50:51], v[40:41], v[42:43] op_sel:[1,1] op_sel_hi:[1,0]
  v_pk_fma_f32 v[36:37], v[46:47], v[28:29], v[38:39] op_sel:[0,0,0] op_sel_hi:[0,1,1] neg_lo:[0,0,1]
  v_pk_fma_f32 v[40:41], v[40:41], v[42:43], v[50:51] op_sel:[0,0,0] op_sel_hi:[0,1,1] neg_lo:[0,0,1]
  v_cvt_pk_bf16_f32 v44, v36, v37
  v_cvt_pk_bf16_f32 v45, v40, v41
  ds_write_b32 v4, v44 offset:3264
  ds_write_b32 v4, v45 offset:11968
  v_pk_mul_f32 v[38:39], v[36:37], v[28:29] op_sel:[1,1] op_sel_hi:[1,0]
  v_pk_mul_f32 v[50:51], v[40:41], v[42:43] op_sel:[1,1] op_sel_hi:[1,0]
  v_pk_fma_f32 v[36:37], v[36:37], v[28:29], v[38:39] op_sel:[0,0,0] op_sel_hi:[0,1,1] neg_lo:[0,0,1]
  v_pk_fma_f32 v[40:41], v[40:41], v[42:43], v[50:51] op_sel:[0,0,0] op_sel_hi:[0,1,1] neg_lo:[0,0,1]
  v_cvt_pk_bf16_f32 v44, v36, v37
  v_cvt_pk_bf16_f32 v45, v40, v41
  ds_write_b32 v4, v44 offset:3536
  ds_write_b32 v4, v45 offset:12240
  v_pk_mul_f32 v[38:39], v[46:47], v[32:33] op_sel:[1,1] op_sel_hi:[1,0]
  v_pk_mul_f32 v[50:51], v[40:41], v[42:43] op_sel:[1,1] op_sel_hi:[1,0]
  v_pk_fma_f32 v[46:47], v[46:47], v[32:33], v[38:39] op_sel:[0,0,0] op_sel_hi:[0,1,1] neg_lo:[0,0,1]
  v_pk_fma_f32 v[40:41], v[40:41], v[42:43], v[50:51] op_sel:[0,0,0] op_sel_hi:[0,1,1] neg_lo:[0,0,1]
  v_cvt_pk_bf16_f32 v44, v46, v47
  v_cvt_pk_bf16_f32 v45, v40, v41
  ds_write_b32 v4, v44 offset:3808
  ds_write_b32 v4, v45 offset:12512
  v_pk_mul_f32 v[38:39], v[46:47], v[30:31] op_sel:[1,1] op_sel_hi:[1,0]
  v_pk_mul_f32 v[50:51], v[40:41], v[42:43] op_sel:[1,1] op_sel_hi:[1,0]
  v_pk_fma_f32 v[36:37], v[46:47], v[30:31], v[38:39] op_sel:[0,0,0] op_sel_hi:[0,1,1] neg_lo:[0,0,1]
  v_pk_fma_f32 v[40:41], v[40:41], v[42:43], v[50:51] op_sel:[0,0,0] op_sel_hi:[0,1,1] neg_lo:[0,0,1]
  v_cvt_pk_bf16_f32 v44, v36, v37
  v_cvt_pk_bf16_f32 v45, v40, v41
  ds_write_b32 v4, v44 offset:4080
  ds_write_b32 v4, v45 offset:12784
  v_pk_mul_f32 v[38:39], v[46:47], v[32:33] op_sel:[1,1] op_sel_hi:[1,0]
  v_pk_mul_f32 v[50:51], v[40:41], v[42:43] op_sel:[1,1] op_sel_hi:[1,0]
  v_pk_fma_f32 v[46:47], v[46:47], v[32:33], v[38:39] op_sel:[0,0,0] op_sel_hi:[0,1,1] neg_lo:[0,0,1]
  v_pk_fma_f32 v[40:41], v[40:41], v[42:43], v[50:51] op_sel:[0,0,0] op_sel_hi:[0,1,1] neg_lo:[0,0,1]
  v_cvt_pk_bf16_f32 v44, v46, v47
  v_cvt_pk_bf16_f32 v45, v40, v41
  ds_write_b32 v4, v44 offset:5440
  ds_write_b32 v4, v45 offset:13056
  v_pk_mul_f32 v[38:39], v[46:47], v[30:31] op_sel:[1,1] op_sel_hi:[1,0]
  v_pk_mul_f32 v[50:51], v[40:41], v[42:43] op_sel:[1,1] op_sel_hi:[1,0]
  v_pk_fma_f32 v[36:37], v[46:47], v[30:31], v[38:39] op_sel:[0,0,0] op_sel_hi:[0,1,1] neg_lo:[0,0,1]
  v_pk_fma_f32 v[40:41], v[40:41], v[42:43], v[50:51] op_sel:[0,0,0] op_sel_hi:[0,1,1] neg_lo:[0,0,1]
  v_cvt_pk_bf16_f32 v44, v36, v37
  v_cvt_pk_bf16_f32 v45, v40, v41
  ds_write_b32 v4, v44 offset:5712
  ds_write_b32 v4, v45 offset:13328
  v_pk_mul_f32 v[38:39], v[46:47], v[32:33] op_sel:[1,1] op_sel_hi:[1,0]
  v_pk_mul_f32 v[50:51], v[40:41], v[42:43] op_sel:[1,1] op_sel_hi:[1,0]
  v_pk_fma_f32 v[46:47], v[46:47], v[32:33], v[38:39] op_sel:[0,0,0] op_sel_hi:[0,1,1] neg_lo:[0,0,1]
  v_pk_fma_f32 v[40:41], v[40:41], v[42:43], v[50:51] op_sel:[0,0,0] op_sel_hi:[0,1,1] neg_lo:[0,0,1]
  v_cvt_pk_bf16_f32 v44, v46, v47
  v_cvt_pk_bf16_f32 v45, v40, v41
  ds_write_b32 v4, v44 offset:5984
  ds_write_b32 v4, v45 offset:13600
  v_pk_mul_f32 v[38:39], v[46:47], v[30:31] op_sel:[1,1] op_sel_hi:[1,0]
  v_pk_mul_f32 v[50:51], v[40:41], v[42:43] op_sel:[1,1] op_sel_hi:[1,0]
  v_pk_fma_f32 v[36:37], v[46:47], v[30:31], v[38:39] op_sel:[0,0,0] op_sel_hi:[0,1,1] neg_lo:[0,0,1]
  v_pk_fma_f32 v[40:41], v[40:41], v[42:43], v[50:51] op_sel:[0,0,0] op_sel_hi:[0,1,1] neg_lo:[0,0,1]
  v_cvt_pk_bf16_f32 v44, v36, v37
  v_cvt_pk_bf16_f32 v45, v40, v41
  ds_write_b32 v4, v44 offset:6256
  ds_write_b32 v4, v45 offset:13872
  v_pk_mul_f32 v[38:39], v[46:47], v[32:33] op_sel:[1,1] op_sel_hi:[1,0]
  v_pk_mul_f32 v[50:51], v[40:41], v[42:43] op_sel:[1,1] op_sel_hi:[1,0]
  v_pk_fma_f32 v[46:47], v[46:47], v[32:33], v[38:39] op_sel:[0,0,0] op_sel_hi:[0,1,1] neg_lo:[0,0,1]
  v_pk_fma_f32 v[40:41], v[40:41], v[42:43], v[50:51] op_sel:[0,0,0] op_sel_hi:[0,1,1] neg_lo:[0,0,1]
  v_cvt_pk_bf16_f32 v44, v46, v47
  v_cvt_pk_bf16_f32 v45, v40, v41
  ds_write_b32 v4, v44 offset:6800
  ds_write_b32 v4, v45 offset:14144
  v_pk_mul_f32 v[38:39], v[46:47], v[30:31] op_sel:[1,1] op_sel_hi:[1,0]
  v_pk_mul_f32 v[50:51], v[40:41], v[42:43] op_sel:[1,1] op_sel_hi:[1,0]
  v_pk_fma_f32 v[36:37], v[46:47], v[30:31], v[38:39] op_sel:[0,0,0] op_sel_hi:[0,1,1] neg_lo:[0,0,1]
  v_pk_fma_f32 v[40:41], v[40:41], v[42:43], v[50:51] op_sel:[0,0,0] op_sel_hi:[0,1,1] neg_lo:[0,0,1]
  v_cvt_pk_bf16_f32 v44, v36, v37
  v_cvt_pk_bf16_f32 v45, v40, v41
  ds_write_b32 v4, v44 offset:7072
  ds_write_b32 v4, v45 offset:14416
  v_pk_mul_f32 v[50:51], v[40:41], v[42:43] op_sel:[1,1] op_sel_hi:[1,0]
  v_pk_fma_f32 v[40:41], v[40:41], v[42:43], v[50:51] op_sel:[0,0,0] op_sel_hi:[0,1,1] neg_lo:[0,0,1]
  v_cvt_pk_bf16_f32 v45, v40, v41
  ds_write_b32 v4, v45 offset:14688
  v_pk_mul_f32 v[50:51], v[40:41], v[42:43] op_sel:[1,1] op_sel_hi:[1,0]
  v_pk_fma_f32 v[40:41], v[40:41], v[42:43], v[50:51] op_sel:[0,0,0] op_sel_hi:[0,1,1] neg_lo:[0,0,1]
  v_cvt_pk_bf16_f32 v45, v40, v41
  ds_write_b32 v4, v45 offset:14960
  v_pk_mul_f32 v[50:51], v[40:41], v[42:43] op_sel:[1,1] op_sel_hi:[1,0]
  v_pk_fma_f32 v[40:41], v[40:41], v[42:43], v[50:51] op_sel:[0,0,0] op_sel_hi:[0,1,1] neg_lo:[0,0,1]
  v_cvt_pk_bf16_f32 v45, v40, v41
  ds_write_b32 v4, v45 offset:15232
  v_pk_mul_f32 v[50:51], v[40:41], v[42:43] op_sel:[1,1] op_sel_hi:[1,0]
  v_pk_fma_f32 v[40:41], v[40:41], v[42:43], v[50:51] op_sel:[0,0,0] op_sel_hi:[0,1,1] neg_lo:[0,0,1]
  v_cvt_pk_bf16_f32 v45, v40, v41
  ds_write_b32 v4, v45 offset:15504
  v_pk_mul_f32 v[50:51], v[40:41], v[42:43] op_sel:[1,1] op_sel_hi:[1,0]
  v_pk_fma_f32 v[40:41], v[40:41], v[42:43], v[50:51] op_sel:[0,0,0] op_sel_hi:[0,1,1] neg_lo:[0,0,1]
  v_cvt_pk_bf16_f32 v45, v40, v41
  ds_write_b32 v4, v45 offset:15776
  s_waitcnt lgkmcnt(0)
  ds_read_b128 v[60:63], v5 offset:0
  ds_read_b128 v[64:67], v21 offset:7344
  ds_read_b128 v[68:71], v5 offset:32
  ds_read_b128 v[72:75], v21 offset:7376
  ds_read_b128 v[76:79], v5 offset:64
  ds_read_b128 v[80:83], v21 offset:7408
  ds_read_b128 v[84:87], v5 offset:96
  ds_read_b128 v[88:91], v21 offset:7440
  s_waitcnt lgkmcnt(6)
  v_mfma_f32_32x32x16_bf16 v[96:111], v[60:63], v[64:67], 0
  s_waitcnt lgkmcnt(4)
  v_mfma_f32_32x32x16_bf16 v[96:111], v[68:71], v[72:75], v[96:111]
  s_waitcnt lgkmcnt(2)
  v_mfma_f32_32x32x16_bf16 v[96:111], v[76:79], v[80:83], v[96:111]
  s_waitcnt lgkmcnt(0)
  v_mfma_f32_32x32x16_bf16 v[96:111], v[84:87], v[88:91], v[96:111]
  ds_read_b128 v[60:63], v5 offset:128
  ds_read_b128 v[64:67], v21 offset:7472
  ds_read_b128 v[68:71], v5 offset:160
  ds_read_b128 v[72:75], v21 offset:7504
  ds_read_b128 v[76:79], v5 offset:192
  ds_read_b128 v[80:83], v21 offset:7536
  ds_read_b128 v[84:87], v5 offset:224
  ds_read_b128 v[88:91], v21 offset:7568
  s_waitcnt lgkmcnt(6)
  v_mfma_f32_32x32x16_bf16 v[96:111], v[60:63], v[64:67], v[96:111]
  s_waitcnt lgkmcnt(4)
  v_mfma_f32_32x32x16_bf16 v[96:111], v[68:71], v[72:75], v[96:111]
  s_waitcnt lgkmcnt(2)
  v_mfma_f32_32x32x16_bf16 v[96:111], v[76:79], v[80:83], v[96:111]
  s_waitcnt lgkmcnt(0)
  v_mfma_f32_32x32x16_bf16 v[96:111], v[84:87], v[88:91], v[96:111]
  v_lshlrev_b32 v118, 16, v118
  v_lshlrev_b32 v119, 16, v119
  v_lshlrev_b32 v120, 16, v120
  v_lshlrev_b32 v121, 16, v121
  v_lshlrev_b32 v122, 16, v122
  v_lshlrev_b32 v123, 16, v123
  v_mul_f32 v22, v20, v118
  v_mul_f32 v23, v20, v119
  s_mov_b32 s7, 0x3fb8aa3b
  v_mul_f32 v22, s7, v22
  v_mul_f32 v23, 0x3e22f983, v23
  v_mul_f32 v120, v20, v120
  v_mul_f32 v121, v20, v121
  v_mul_f32 v38, v123, v121
  v_fma_f32 v34, v122, v120, -v38
  v_mul_f32 v38, v123, v120
  v_fma_f32 v35, v122, v121, v38
  v_exp_f32 v38, v22
  v_fract_f32 v39, v23
  v_cos_f32 v24, v39
  v_sin_f32 v25, v39
  s_nop 0
  v_mul_f32 v24, v24, v38
  v_mul_f32 v25, v25, v38
  v_mul_f32 v38, 0x43800000, v22
  v_mul_f32 v39, 0x43800000, v23
  v_exp_f32 v38, v38
  v_fract_f32 v39, v39
  v_cos_f32 v32, v39
  v_sin_f32 v33, v39
  s_nop 0
  v_mul_f32 v32, v32, v38
  v_mul_f32 v33, v33, v38
  v_pk_mul_f32 v[38:39], v[24:25], v[24:25] op_sel:[1,1] op_sel_hi:[1,0]
  v_pk_fma_f32 v[26:27], v[24:25], v[24:25], v[38:39] op_sel:[0,0,0] op_sel_hi:[0,1,1] neg_lo:[0,0,1]
  v_pk_mul_f32 v[38:39], v[26:27], v[26:27] op_sel:[1,1] op_sel_hi:[1,0]
  v_pk_fma_f32 v[28:29], v[26:27], v[26:27], v[38:39] op_sel:[0,0,0] op_sel_hi:[0,1,1] neg_lo:[0,0,1]
  v_pk_mul_f32 v[38:39], v[28:29], v[28:29] op_sel:[1,1] op_sel_hi:[1,0]
  v_pk_fma_f32 v[30:31], v[28:29], v[28:29], v[38:39] op_sel:[0,0,0] op_sel_hi:[0,1,1] neg_lo:[0,0,1]
  v_mov_b32 v42, v30
  v_xor_b32 v43, 0x80000000, v31
  v_cvt_pk_bf16_f32 v44, v34, v35
  v_mov_b32 v40, 1.0
  ds_write_b32 v4, v44 offset:0
  v_mov_b32 v41, 0
  v_cvt_pk_bf16_f32 v45, v40, v41
  ds_write_b32 v4, v45 offset:7344
  v_pk_mul_f32 v[38:39], v[34:35], v[24:25] op_sel:[1,1] op_sel_hi:[1,0]
  v_pk_mul_f32 v[50:51], v[40:41], v[42:43] op_sel:[1,1] op_sel_hi:[1,0]
  v_pk_fma_f32 v[36:37], v[34:35], v[24:25], v[38:39] op_sel:[0,0,0] op_sel_hi:[0,1,1] neg_lo:[0,0,1]
  v_pk_fma_f32 v[40:41], v[40:41], v[42:43], v[50:51] op_sel:[0,0,0] op_sel_hi:[0,1,1] neg_lo:[0,0,1]
  v_cvt_pk_bf16_f32 v44, v36, v37
  v_cvt_pk_bf16_f32 v45, v40, v41
  ds_write_b32 v4, v44 offset:272
  ds_write_b32 v4, v45 offset:7616
  v_pk_mul_f32 v[38:39], v[36:37], v[24:25] op_sel:[1,1] op_sel_hi:[1,0]
  v_pk_mul_f32 v[50:51], v[40:41], v[42:43] op_sel:[1,1] op_sel_hi:[1,0]
  v_pk_fma_f32 v[36:37], v[36:37], v[24:25], v[38:39] op_sel:[0,0,0] op_sel_hi:[0,1,1] neg_lo:[0,0,1]
  v_pk_fma_f32 v[40:41], v[40:41], v[42:43], v[50:51] op_sel:[0,0,0] op_sel_hi:[0,1,1] neg_lo:[0,0,1]
  v_cvt_pk_bf16_f32 v44, v36, v37
  v_cvt_pk_bf16_f32 v45, v40, v41
  ds_write_b32 v4, v44 offset:544
  ds_write_b32 v4, v45 offset:7888
  v_pk_mul_f32 v[38:39], v[36:37], v[24:25] op_sel:[1,1] op_sel_hi:[1,0]
  v_pk_mul_f32 v[50:51], v[40:41], v[42:43] op_sel:[1,1] op_sel_hi:[1,0]
  v_pk_fma_f32 v[36:37], v[36:37], v[24:25], v[38:39] op_sel:[0,0,0] op_sel_hi:[0,1,1] neg_lo:[0,0,1]
  v_pk_fma_f32 v[40:41], v[40:41], v[42:43], v[50:51] op_sel:[0,0,0] op_sel_hi:[0,1,1] neg_lo:[0,0,1]
  v_cvt_pk_bf16_f32 v44, v36, v37
  v_cvt_pk_bf16_f32 v45, v40, v41
  ds_write_b32 v4, v44 offset:816
  ds_write_b32 v4, v45 offset:8160
  v_pk_mul_f32 v[38:39], v[36:37], v[24:25] op_sel:[1,1] op_sel_hi:[1,0]
  v_pk_mul_f32 v[50:51], v[40:41], v[42:43] op_sel:[1,1] op_sel_hi:[1,0]
  v_pk_fma_f32 v[36:37], v[36:37], v[24:25], v[38:39] op_sel:[0,0,0] op_sel_hi:[0,1,1] neg_lo:[0,0,1]
  v_pk_fma_f32 v[40:41], v[40:41], v[42:43], v[50:51] op_sel:[0,0,0] op_sel_hi:[0,1,1] neg_lo:[0,0,1]
  v_cvt_pk_bf16_f32 v44, v36, v37
  v_cvt_pk_bf16_f32 v45, v40, v41
  ds_write_b32 v4, v44 offset:2176
  ds_write_b32 v4, v45 offset:8432
  v_pk_mul_f32 v[38:39], v[36:37], v[24:25] op_sel:[1,1] op_sel_hi:[1,0]
  v_pk_mul_f32 v[50:51], v[40:41], v[42:43] op_sel:[1,1] op_sel_hi:[1,0]
  v_pk_fma_f32 v[36:37], v[36:37], v[24:25], v[38:39] op_sel:[0,0,0] op_sel_hi:[0,1,1] neg_lo:[0,0,1]
  v_pk_fma_f32 v[40:41], v[40:41], v[42:43], v[50:51] op_sel:[0,0,0] op_sel_hi:[0,1,1] neg_lo:[0,0,1]
  v_cvt_pk_bf16_f32 v44, v36, v37
  v_cvt_pk_bf16_f32 v45, v40, v41
  ds_write_b32 v4, v44 offset:2448
  ds_write_b32 v4, v45 offset:8704
  v_pk_mul_f32 v[38:39], v[36:37], v[24:25] op_sel:[1,1] op_sel_hi:[1,0]
  v_pk_mul_f32 v[50:51], v[40:41], v[42:43] op_sel:[1,1] op_sel_hi:[1,0]
  v_pk_fma_f32 v[36:37], v[36:37], v[24:25], v[38:39] op_sel:[0,0,0] op_sel_hi:[0,1,1] neg_lo:[0,0,1]
  v_pk_fma_f32 v[40:41], v[40:41], v[42:43], v[50:51] op_sel:[0,0,0] op_sel_hi:[0,1,1] neg_lo:[0,0,1]
  v_cvt_pk_bf16_f32 v44, v36, v37
  v_cvt_pk_bf16_f32 v45, v40, v41
  ds_write_b32 v4, v44 offset:2720
  ds_write_b32 v4, v45 offset:8976
  v_pk_mul_f32 v[38:39], v[36:37], v[24:25] op_sel:[1,1] op_sel_hi:[1,0]
  v_pk_mul_f32 v[50:51], v[40:41], v[42:43] op_sel:[1,1] op_sel_hi:[1,0]
  v_pk_fma_f32 v[36:37], v[36:37], v[24:25], v[38:39] op_sel:[0,0,0] op_sel_hi:[0,1,1] neg_lo:[0,0,1]
  v_pk_fma_f32 v[40:41], v[40:41], v[42:43], v[50:51] op_sel:[0,0,0] op_sel_hi:[0,1,1] neg_lo:[0,0,1]
  v_cvt_pk_bf16_f32 v44, v36, v37
  v_cvt_pk_bf16_f32 v45, v40, v41
  ds_write_b32 v4, v44 offset:2992
  ds_write_b32 v4, v45 offset:9248
  v_pk_mul_f32 v[38:39], v[34:35], v[32:33] op_sel:[1,1] op_sel_hi:[1,0]
  v_pk_mul_f32 v[50:51], v[40:41], v[42:43] op_sel:[1,1] op_sel_hi:[1,0]
  v_pk_fma_f32 v[46:47], v[34:35], v[32:33], v[38:39] op_sel:[0,0,0] op_sel_hi:[0,1,1] neg_lo:[0,0,1]
  v_pk_fma_f32 v[40:41], v[40:41], v[42:43], v[50:51] op_sel:[0,0,0] op_sel_hi:[0,1,1] neg_lo:[0,0,1]
  v_cvt_pk_bf16_f32 v44, v46, v47
  v_cvt_pk_bf16_f32 v45, v40, v41
  ds_write_b32 v4, v44 offset:4352
  ds_write_b32 v4, v45 offset:9520
  v_pk_mul_f32 v[38:39], v[46:47], v[26:27] op_sel:[1,1] op_sel_hi:[1,0]
  v_pk_mul_f32 v[50:51], v[40:41], v[42:43] op_sel:[1,1] op_sel_hi:[1,0]
  v_pk_fma_f32 v[36:37], v[46:47], v[26:27], v[38:39] op_sel:[0,0,0] op_sel_hi:[0,1,1] neg_lo:[0,0,1]
  v_pk_fma_f32 v[40:41], v[40:41], v[42:43], v[50:51] op_sel:[0,0,0] op_sel_hi:[0,1,1] neg_lo:[0,0,1]
  v_cvt_pk_bf16_f32 v44, v36, v37
  v_cvt_pk_bf16_f32 v45, v40, v41
  ds_write_b32 v4, v44 offset:4624
  ds_write_b32 v4, v45 offset:9792
  v_pk_mul_f32 v[38:39], v[36:37], v[26:27] op_sel:[1,1] op_sel_hi:[1,0]
  v_pk_mul_f32 v[50:51], v[40:41], v[42:43] op_sel:[1,1] op_sel_hi:[1,0]
  v_pk_fma_f32 v[36:37], v[36:37], v[26:27], v[38:39] op_sel:[0,0,0] op_sel_hi:[0,1,1] neg_lo:[0,0,1]
  v_pk_fma_f32 v[40:41], v[40:41], v[42:43], v[50:51] op_sel:[0,0,0] op_sel_hi:[0,1,1] neg_lo:[0,0,1]
  v_cvt_pk_bf16_f32 v44, v36, v37
  v_cvt_pk_bf16_f32 v45, v40, v41
  ds_write_b32 v4, v44 offset:4896
  ds_write_b32 v4, v45 offset:10064
  v_pk_mul_f32 v[38:39], v[36:37], v[26:27] op_sel:[1,1] op_sel_hi:[1,0]
  v_pk_mul_f32 v[50:51], v[40:41], v[42:43] op_sel:[1,1] op_sel_hi:[1,0]
  v_pk_fma_f32 v[36:37], v[36:37], v[26:27], v[38:39] op_sel:[0,0,0] op_sel_hi:[0,1,1] neg_lo:[0,0,1]
  v_pk_fma_f32 v[40:41], v[40:41], v[42:43], v[50:51] op_sel:[0,0,0] op_sel_hi:[0,1,1] neg_lo:[0,0,1]
  v_cvt_pk_bf16_f32 v44, v36, v37
  v_cvt_pk_bf16_f32 v45, v40, v41
  ds_write_b32 v4, v44 offset:5168
  ds_write_b32 v4, v45 offset:10336
  v_pk_mul_f32 v[38:39], v[36:37], v[26:27] op_sel:[1,1] op_sel_hi:[1,0]
  v_pk_mul_f32 v[50:51], v[40:41], v[42:43] op_sel:[1,1] op_sel_hi:[1,0]
  v_pk_fma_f32 v[36:37], v[36:37], v[26:27], v[38:39] op_sel:[0,0,0] op_sel_hi:[0,1,1] neg_lo:[0,0,1]
  v_pk_fma_f32 v[40:41], v[40:41], v[42:43], v[50:51] op_sel:[0,0,0] op_sel_hi:[0,1,1] neg_lo:[0,0,1]
  v_cvt_pk_bf16_f32 v44, v36, v37
  v_cvt_pk_bf16_f32 v45, v40, v41
  ds_write_b32 v4, v44 offset:6528
  ds_write_b32 v4, v45 offset:10608
  v_pk_mul_f32 v[38:39], v[46:47], v[32:33] op_sel:[1,1] op_sel_hi:[1,0]
  v_pk_mul_f32 v[50:51], v[40:41], v[42:43] op_sel:[1,1] op_sel_hi:[1,0]
  v_pk_fma_f32 v[46:47], v[46:47], v[32:33], v[38:39] op_sel:[0,0,0] op_sel_hi:[0,1,1] neg_lo:[0,0,1]
  v_pk_fma_f32 v[40:41], v[40:41], v[42:43], v[50:51] op_sel:[0,0,0] op_sel_hi:[0,1,1] neg_lo:[0,0,1]
  v_cvt_pk_bf16_f32 v44, v46, v47
  v_cvt_pk_bf16_f32 v45, v40, v41
  ds_write_b32 v4, v44 offset:1088
  ds_write_b32 v4, v45 offset:10880
  v_pk_mul_f32 v[38:39], v[46:47], v[28:29] op_sel:[1,1] op_sel_hi:[1,0]
  v_pk_mul_f32 v[50:51], v[40:41], v[42:43] op_sel:[1,1] op_sel_hi:[1,0]
  v_pk_fma_f32 v[36:37], v[46:47], v[28:29], v[38:39] op_sel:[0,0,0] op_sel_hi:[0,1,1] neg_lo:[0,0,1]
  v_pk_fma_f32 v[40:41], v[40:41], v[42:43], v[50:51] op_sel:[0,0,0] op_sel_hi:[0,1,1] neg_lo:[0,0,1]
  v_cvt_pk_bf16_f32 v44, v36, v37
  v_cvt_pk_bf16_f32 v45, v40, v41
  ds_write_b32 v4, v44 offset:1360
  ds_write_b32 v4, v45 offset:11152
  v_pk_mul_f32 v[38:39], v[36:37], v[28:29] op_sel:[1,1] op_sel_hi:[1,0]
  v_pk_mul_f32 v[50:51], v[40:41], v[42:43] op_sel:[1,1] op_sel_hi:[1,0]
  v_pk_fma_f32 v[36:37], v[36:37], v[28:29], v[38:39] op_sel:[0,0,0] op_sel_hi:[0,1,1] neg_lo:[0,0,1]
  v_pk_fma_f32 v[40:41], v[40:41], v[42:43], v[50:51] op_sel:[0,0,0] op_sel_hi:[0,1,1] neg_lo:[0,0,1]
  v_cvt_pk_bf16_f32 v44, v36, v37
  v_cvt_pk_bf16_f32 v45, v40, v41
  ds_write_b32 v4, v44 offset:1632
  ds_write_b32 v4, v45 offset:11424
  v_pk_mul_f32 v[38:39], v[46:47], v[32:33] op_sel:[1,1] op_sel_hi:[1,0]
  v_pk_mul_f32 v[50:51], v[40:41], v[42:43] op_sel:[1,1] op_sel_hi:[1,0]
  v_pk_fma_f32 v[46:47], v[46:47], v[32:33], v[38:39] op_sel:[0,0,0] op_sel_hi:[0,1,1] neg_lo:[0,0,1]
  v_pk_fma_f32 v[40:41], v[40:41], v[42:43], v[50:51] op_sel:[0,0,0] op_sel_hi:[0,1,1] neg_lo:[0,0,1]
  v_cvt_pk_bf16_f32 v44, v46, v47
  v_cvt_pk_bf16_f32 v45, v40, v41
  ds_write_b32 v4, v44 offset:1904
  ds_write_b32 v4, v45 offset:11696
  v_pk_mul_f32 v[38:39], v[46:47], v[28:29] op_sel:[1,1] op_sel_hi:[1,0]
  v_pk_mul_f32 v[50:51], v[40:41], v[42:43] op_sel:[1,1] op_sel_hi:[1,0]
  v_pk_fma_f32 v[36:37], v[46:47], v[28:29], v[38:39] op_sel:[0,0,0] op_sel_hi:[0,1,1] neg_lo:[0,0,1]
  v_pk_fma_f32 v[40:41], v[40:41], v[42:43], v[50:51] op_sel:[0,0,0] op_sel_hi:[0,1,1] neg_lo:[0,0,1]
  v_cvt_pk_bf16_f32 v44, v36, v37
  v_cvt_pk_bf16_f32 v45, v40, v41
  ds_write_b32 v4, v44 offset:3264
  ds_write_b32 v4, v45 offset:11968
  v_pk_mul_f32 v[38:39], v[36:37], v[28:29] op_sel:[1,1] op_sel_hi:[1,0]
  v_pk_mul_f32 v[50:51], v[40:41], v[42:43] op_sel:[1,1] op_sel_hi:[1,0]
  v_pk_fma_f32 v[36:37], v[36:37], v[28:29], v[38:39] op_sel:[0,0,0] op_sel_hi:[0,1,1] neg_lo:[0,0,1]
  v_pk_fma_f32 v[40:41], v[40:41], v[42:43], v[50:51] op_sel:[0,0,0] op_sel_hi:[0,1,1] neg_lo:[0,0,1]
  v_cvt_pk_bf16_f32 v44, v36, v37
  v_cvt_pk_bf16_f32 v45, v40, v41
  ds_write_b32 v4, v44 offset:3536
  ds_write_b32 v4, v45 offset:12240
  v_pk_mul_f32 v[38:39], v[46:47], v[32:33] op_sel:[1,1] op_sel_hi:[1,0]
  v_pk_mul_f32 v[50:51], v[40:41], v[42:43] op_sel:[1,1] op_sel_hi:[1,0]
  v_pk_fma_f32 v[46:47], v[46:47], v[32:33], v[38:39] op_sel:[0,0,0] op_sel_hi:[0,1,1] neg_lo:[0,0,1]
  v_pk_fma_f32 v[40:41], v[40:41], v[42:43], v[50:51] op_sel:[0,0,0] op_sel_hi:[0,1,1] neg_lo:[0,0,1]
  v_cvt_pk_bf16_f32 v44, v46, v47
  v_cvt_pk_bf16_f32 v45, v40, v41
  ds_write_b32 v4, v44 offset:3808
  ds_write_b32 v4, v45 offset:12512
  v_pk_mul_f32 v[38:39], v[46:47], v[30:31] op_sel:[1,1] op_sel_hi:[1,0]
  v_pk_mul_f32 v[50:51], v[40:41], v[42:43] op_sel:[1,1] op_sel_hi:[1,0]
  v_pk_fma_f32 v[36:37], v[46:47], v[30:31], v[38:39] op_sel:[0,0,0] op_sel_hi:[0,1,1] neg_lo:[0,0,1]
  v_pk_fma_f32 v[40:41], v[40:41], v[42:43], v[50:51] op_sel:[0,0,0] op_sel_hi:[0,1,1] neg_lo:[0,0,1]
  v_cvt_pk_bf16_f32 v44, v36, v37
  v_cvt_pk_bf16_f32 v45, v40, v41
  ds_write_b32 v4, v44 offset:4080
  ds_write_b32 v4, v45 offset:12784
  v_pk_mul_f32 v[38:39], v[46:47], v[32:33] op_sel:[1,1] op_sel_hi:[1,0]
  v_pk_mul_f32 v[50:51], v[40:41], v[42:43] op_sel:[1,1] op_sel_hi:[1,0]
  v_pk_fma_f32 v[46:47], v[46:47], v[32:33], v[38:39] op_sel:[0,0,0] op_sel_hi:[0,1,1] neg_lo:[0,0,1]
  v_pk_fma_f32 v[40:41], v[40:41], v[42:43], v[50:51] op_sel:[0,0,0] op_sel_hi:[0,1,1] neg_lo:[0,0,1]
  v_cvt_pk_bf16_f32 v44, v46, v47
  v_cvt_pk_bf16_f32 v45, v40, v41
  ds_write_b32 v4, v44 offset:5440
  ds_write_b32 v4, v45 offset:13056
  v_pk_mul_f32 v[38:39], v[46:47], v[30:31] op_sel:[1,1] op_sel_hi:[1,0]
  v_pk_mul_f32 v[50:51], v[40:41], v[42:43] op_sel:[1,1] op_sel_hi:[1,0]
  v_pk_fma_f32 v[36:37], v[46:47], v[30:31], v[38:39] op_sel:[0,0,0] op_sel_hi:[0,1,1] neg_lo:[0,0,1]
  v_pk_fma_f32 v[40:41], v[40:41], v[42:43], v[50:51] op_sel:[0,0,0] op_sel_hi:[0,1,1] neg_lo:[0,0,1]
  v_cvt_pk_bf16_f32 v44, v36, v37
  v_cvt_pk_bf16_f32 v45, v40, v41
  ds_write_b32 v4, v44 offset:5712
  ds_write_b32 v4, v45 offset:13328
  v_pk_mul_f32 v[38:39], v[46:47], v[32:33] op_sel:[1,1] op_sel_hi:[1,0]
  v_pk_mul_f32 v[50:51], v[40:41], v[42:43] op_sel:[1,1] op_sel_hi:[1,0]
  v_pk_fma_f32 v[46:47], v[46:47], v[32:33], v[38:39] op_sel:[0,0,0] op_sel_hi:[0,1,1] neg_lo:[0,0,1]
  v_pk_fma_f32 v[40:41], v[40:41], v[42:43], v[50:51] op_sel:[0,0,0] op_sel_hi:[0,1,1] neg_lo:[0,0,1]
  v_cvt_pk_bf16_f32 v44, v46, v47
  v_cvt_pk_bf16_f32 v45, v40, v41
  ds_write_b32 v4, v44 offset:5984
  ds_write_b32 v4, v45 offset:13600
  v_pk_mul_f32 v[38:39], v[46:47], v[30:31] op_sel:[1,1] op_sel_hi:[1,0]
  v_pk_mul_f32 v[50:51], v[40:41], v[42:43] op_sel:[1,1] op_sel_hi:[1,0]
  v_pk_fma_f32 v[36:37], v[46:47], v[30:31], v[38:39] op_sel:[0,0,0] op_sel_hi:[0,1,1] neg_lo:[0,0,1]
  v_pk_fma_f32 v[40:41], v[40:41], v[42:43], v[50:51] op_sel:[0,0,0] op_sel_hi:[0,1,1] neg_lo:[0,0,1]
  v_cvt_pk_bf16_f32 v44, v36, v37
  v_cvt_pk_bf16_f32 v45, v40, v41
  ds_write_b32 v4, v44 offset:6256
  ds_write_b32 v4, v45 offset:13872
  v_pk_mul_f32 v[38:39], v[46:47], v[32:33] op_sel:[1,1] op_sel_hi:[1,0]
  v_pk_mul_f32 v[50:51], v[40:41], v[42:43] op_sel:[1,1] op_sel_hi:[1,0]
  v_pk_fma_f32 v[46:47], v[46:47], v[32:33], v[38:39] op_sel:[0,0,0] op_sel_hi:[0,1,1] neg_lo:[0,0,1]
  v_pk_fma_f32 v[40:41], v[40:41], v[42:43], v[50:51] op_sel:[0,0,0] op_sel_hi:[0,1,1] neg_lo:[0,0,1]
  v_cvt_pk_bf16_f32 v44, v46, v47
  v_cvt_pk_bf16_f32 v45, v40, v41
  ds_write_b32 v4, v44 offset:6800
  ds_write_b32 v4, v45 offset:14144
  v_pk_mul_f32 v[38:39], v[46:47], v[30:31] op_sel:[1,1] op_sel_hi:[1,0]
  v_pk_mul_f32 v[50:51], v[40:41], v[42:43] op_sel:[1,1] op_sel_hi:[1,0]
  v_pk_fma_f32 v[36:37], v[46:47], v[30:31], v[38:39] op_sel:[0,0,0] op_sel_hi:[0,1,1] neg_lo:[0,0,1]
  v_pk_fma_f32 v[40:41], v[40:41], v[42:43], v[50:51] op_sel:[0,0,0] op_sel_hi:[0,1,1] neg_lo:[0,0,1]
  v_cvt_pk_bf16_f32 v44, v36, v37
  v_cvt_pk_bf16_f32 v45, v40, v41
  ds_write_b32 v4, v44 offset:7072
  ds_write_b32 v4, v45 offset:14416
  v_pk_mul_f32 v[50:51], v[40:41], v[42:43] op_sel:[1,1] op_sel_hi:[1,0]
  v_pk_fma_f32 v[40:41], v[40:41], v[42:43], v[50:51] op_sel:[0,0,0] op_sel_hi:[0,1,1] neg_lo:[0,0,1]
  v_cvt_pk_bf16_f32 v45, v40, v41
  ds_write_b32 v4, v45 offset:14688
  v_pk_mul_f32 v[50:51], v[40:41], v[42:43] op_sel:[1,1] op_sel_hi:[1,0]
  v_pk_fma_f32 v[40:41], v[40:41], v[42:43], v[50:51] op_sel:[0,0,0] op_sel_hi:[0,1,1] neg_lo:[0,0,1]
  v_cvt_pk_bf16_f32 v45, v40, v41
  ds_write_b32 v4, v45 offset:14960
  v_pk_mul_f32 v[50:51], v[40:41], v[42:43] op_sel:[1,1] op_sel_hi:[1,0]
  v_pk_fma_f32 v[40:41], v[40:41], v[42:43], v[50:51] op_sel:[0,0,0] op_sel_hi:[0,1,1] neg_lo:[0,0,1]
  v_cvt_pk_bf16_f32 v45, v40, v41
  ds_write_b32 v4, v45 offset:15232
  v_pk_mul_f32 v[50:51], v[40:41], v[42:43] op_sel:[1,1] op_sel_hi:[1,0]
  v_pk_fma_f32 v[40:41], v[40:41], v[42:43], v[50:51] op_sel:[0,0,0] op_sel_hi:[0,1,1] neg_lo:[0,0,1]
  v_cvt_pk_bf16_f32 v45, v40, v41
  ds_write_b32 v4, v45 offset:15504
  v_pk_mul_f32 v[50:51], v[40:41], v[42:43] op_sel:[1,1] op_sel_hi:[1,0]
  v_pk_fma_f32 v[40:41], v[40:41], v[42:43], v[50:51] op_sel:[0,0,0] op_sel_hi:[0,1,1] neg_lo:[0,0,1]
  v_cvt_pk_bf16_f32 v45, v40, v41
  ds_write_b32 v4, v45 offset:15776
  s_waitcnt lgkmcnt(0)
  ds_read_b128 v[60:63], v5 offset:0
  ds_read_b128 v[64:67], v21 offset:7344
  ds_read_b128 v[68:71], v5 offset:32
  ds_read_b128 v[72:75], v21 offset:7376
  ds_read_b128 v[76:79], v5 offset:64
  ds_read_b128 v[80:83], v21 offset:7408
  ds_read_b128 v[84:87], v5 offset:96
  ds_read_b128 v[88:91], v21 offset:7440
  s_waitcnt lgkmcnt(6)
  v_mfma_f32_32x32x16_bf16 v[96:111], v[60:63], v[64:67], v[96:111]
  s_waitcnt lgkmcnt(4)
  v_mfma_f32_32x32x16_bf16 v[96:111], v[68:71], v[72:75], v[96:111]
  s_waitcnt lgkmcnt(2)
  v_mfma_f32_32x32x16_bf16 v[96:111], v[76:79], v[80:83], v[96:111]
  s_waitcnt lgkmcnt(0)
  v_mfma_f32_32x32x16_bf16 v[96:111], v[84:87], v[88:91], v[96:111]
  ds_read_b128 v[60:63], v5 offset:128
  ds_read_b128 v[64:67], v21 offset:7472
  ds_read_b128 v[68:71], v5 offset:160
  ds_read_b128 v[72:75], v21 offset:7504
  ds_read_b128 v[76:79], v5 offset:192
  ds_read_b128 v[80:83], v21 offset:7536
  ds_read_b128 v[84:87], v5 offset:224
  ds_read_b128 v[88:91], v21 offset:7568
  s_waitcnt lgkmcnt(6)
  v_mfma_f32_32x32x16_bf16 v[96:111], v[60:63], v[64:67], v[96:111]
  s_waitcnt lgkmcnt(4)
  v_mfma_f32_32x32x16_bf16 v[96:111], v[68:71], v[72:75], v[96:111]
  s_waitcnt lgkmcnt(2)
  v_mfma_f32_32x32x16_bf16 v[96:111], v[76:79], v[80:83], v[96:111]
  s_waitcnt lgkmcnt(0)
  v_mfma_f32_32x32x16_bf16 v[96:111], v[84:87], v[88:91], v[96:111]
  s_nop 13
  v_mov_b32 v2, 49128
  s_mov_b32 s82, 0
L_spin_a0_64:
  ds_read_b32 v3, v2
  s_add_u32 s82, s82, 1
  s_waitcnt lgkmcnt(0)
  v_readfirstlane_b32 s7, v3
  s_nop 1
  s_cmp_ge_u32 s7, 1
  s_cbranch_scc1 L_spun_a0_65
  s_cmp_gt_u32 s82, 160000
  s_cbranch_scc1 L_spun_a0_65
  s_sleep 4
  s_branch L_spin_a0_64
L_spun_a0_65:
  s_mul_i32 s56, s95, 4352
  s_add_u32 s56, s56, 53248
  v_and_b32 v2, 31, v0
  v_lshlrev_b32 v2, 4, v2
  v_sub_u32 v2, 4080, v2
  v_add_u32 v2, s56, v2
  v_lshlrev_b32 v3, 2, v0
  v_add_u32 v3, s56, v3
  v_mov_b32 v6, 0
  ds_write_b32 v3, v6 offset:4096
  s_mov_b32 exec_hi, 0
  v_cvt_pk_bf16_f32 v8, v103, v102
  v_cvt_pk_bf16_f32 v9, v101, v100
  v_cvt_pk_bf16_f32 v10, v99, v98
  v_cvt_pk_bf16_f32 v11, v97, v96
  v_subrev_u32 v7, 0, v2
  ds_write_b128 v7, v[8:11]
  s_nop 1
  v_cvt_pk_bf16_f32 v8, v108, v107
  v_cvt_pk_bf16_f32 v9, v106, v106
  v_cvt_pk_bf16_f32 v10, v106, v105
  v_cvt_pk_bf16_f32 v11, v104, v104
  v_subrev_u32 v7, 512, v2
  ds_write_b128 v7, v[8:11]
  s_nop 1
  s_mov_b32 exec_hi, -1
  s_mov_b32 exec_lo, 0
  v_cvt_pk_bf16_f32 v8, v98, v98
  v_cvt_pk_bf16_f32 v9, v97, v97
  v_cvt_pk_bf16_f32 v10, v97, v96
  v_cvt_pk_bf16_f32 v11, v96, v96
  v_subrev_u32 v7, 1024, v2
  ds_write_b128 v7, v[8:11]
  s_nop 1
  v_cvt_pk_bf16_f32 v8, v101, v101
  v_cvt_pk_bf16_f32 v9, v100, v100
  v_cvt_pk_bf16_f32 v10, v100, v99
  v_cvt_pk_bf16_f32 v11, v99, v99
  v_subrev_u32 v7, 1536, v2
  ds_write_b128 v7, v[8:11]
  s_nop 1
  s_mov_b32 s80, 0xaaaaaaaa
  s_mov_b32 s81, 0xaaaaaaaa
  v_cndmask_b32 v6, v102, v103, s[80:81]
  v_cvt_pk_bf16_f32 v8, v103, v103
  v_cvt_pk_bf16_f32 v9, v103, v6
  v_cvt_pk_bf16_f32 v10, v102, v102
  v_cvt_pk_bf16_f32 v11, v102, v102
  v_subrev_u32 v7, 2048, v2
  ds_write_b128 v7, v[8:11]
  s_nop 1
  v_cndmask_b32 v6, v104, v105, s[80:81]
  v_cvt_pk_bf16_f32 v8, v105, v105
  v_cvt_pk_bf16_f32 v9, v105, v6
  v_cvt_pk_bf16_f32 v10, v104, v104
  v_cvt_pk_bf16_f32 v11, v104, v104
  v_subrev_u32 v7, 2560, v2
  ds_write_b128 v7, v[8:11]
  s_nop 1
  v_cndmask_b32 v6, v106, v107, s[80:81]
  v_cvt_pk_bf16_f32 v8, v107, v107
  v_cvt_pk_bf16_f32 v9, v107, v6
  v_cvt_pk_bf16_f32 v10, v106, v106
  v_cvt_pk_bf16_f32 v11, v106, v106
  v_subrev_u32 v7, 3072, v2
  ds_write_b128 v7, v[8:11]
  s_nop 1
  v_cndmask_b32 v6, v108, v109, s[80:81]
  v_cvt_pk_bf16_f32 v8, v109, v109
  v_cvt_pk_bf16_f32 v9, v109, v6
  v_cvt_pk_bf16_f32 v10, v108, v108
  v_cvt_pk_bf16_f32 v11, v108, v108
  v_subrev_u32 v7, 3584, v2
  ds_write_b128 v7, v[8:11]
  s_nop 1
  s_mov_b32 exec_lo, -1
  s_waitcnt lgkmcnt(0)
  s_waitcnt vmcnt(0)
  s_mov_b32 s82, 0
L_nonce_66:
  v_readfirstlane_b32 s92, v126
  s_nop 1
  s_cmp_lg_u32 s92, 0
  s_cbranch_scc1 L_nonce_ok_67
  s_add_u32 s82, s82, 1
  s_cmp_gt_u32 s82, 20000
  s_cbranch_scc1 L_nonce_ok_67
  s_sleep 4
  v_mov_b32 v125, 0
  buffer_load_dword v126, v125, s[20:23], 0 offen sc1
  s_waitcnt vmcnt(0)
  s_branch L_nonce_66
L_nonce_ok_67:
L_role_join_41:
  s_barrier
  s_mov_b32 s58, s6
  s_mul_i32 s56, s58, 13108
  s_lshr_b32 s56, s56, 16
  s_mul_i32 s57, s56, 5
  s_sub_u32 s57, s58, s57
  s_lshl_b32 s57, s57, 6
  v_add_u32 v2, s57, v0
  v_cmp_gt_u32 vcc, 264, v2
  s_and_saveexec_b64 s[90:91], vcc
  v_lshlrev_b32 v2, 4, v2
  s_mul_i32 s57, s56, 4352
  s_add_u32 s57, s57, 53248
  v_add_u32 v3, s57, v2
  ds_read_b128 v[8:11], v3
  ds_read_b64 v[12:13], v3 offset:16
  s_mul_i32 s57, s56, 17664
  v_add_u32 v3, s57, v2
  s_waitcnt lgkmcnt(0)
  v_alignbit_b32 v16, v9, v8, 16
  v_alignbit_b32 v17, v10, v9, 16
  v_alignbit_b32 v18, v11, v10, 16
  v_alignbit_b32 v19, v12, v11, 16
  v_alignbit_b32 v20, v13, v12, 16
  ds_write_b128 v3, v[8:11]
  ds_write_b128 v3, v[16:19] offset:4416
  v_mov_b32 v24, v9
  v_mov_b32 v25, v10
  v_mov_b32 v26, v11
  v_mov_b32 v27, v12
  v_mov_b32 v28, v17
  v_mov_b32 v29, v18
  v_mov_b32 v30, v19
  v_mov_b32 v31, v20
  ds_write_b128 v3, v[24:27] offset:8832
  ds_write_b128 v3, v[28:31] offset:13248
  s_mov_b64 exec, s[90:91]
  s_cmp_ge_u32 s6, 7
  s_cbranch_scc1 L_exp2_69
  s_nop 1
  s_add_u32 s58, s6, 8
  s_mul_i32 s56, s58, 13108
  s_lshr_b32 s56, s56, 16
  s_mul_i32 s57, s56, 5
  s_sub_u32 s57, s58, s57
  s_lshl_b32 s57, s57, 6
  v_add_u32 v2, s57, v0
  v_cmp_gt_u32 vcc, 264, v2
  s_and_saveexec_b64 s[90:91], vcc
  v_lshlrev_b32 v2, 4, v2
  s_mul_i32 s57, s56, 4352
  s_add_u32 s57, s57, 53248
  v_add_u32 v3, s57, v2
  ds_read_b128 v[8:11], v3
  ds_read_b64 v[12:13], v3 offset:16
  s_mul_i32 s57, s56, 17664
  v_add_u32 v3, s57, v2
  s_waitcnt lgkmcnt(0)
  v_alignbit_b32 v16, v9, v8, 16
  v_alignbit_b32 v17, v10, v9, 16
  v_alignbit_b32 v18, v11, v10, 16
  v_alignbit_b32 v19, v12, v11, 16
  v_alignbit_b32 v20, v13, v12, 16
  ds_write_b128 v3, v[8:11]
  ds_write_b128 v3, v[16:19] offset:4416
  v_mov_b32 v24, v9
  v_mov_b32 v25, v10
  v_mov_b32 v26, v11
  v_mov_b32 v27, v12
  v_mov_b32 v28, v17
  v_mov_b32 v29, v18
  v_mov_b32 v30, v19
  v_mov_b32 v31, v20
  ds_write_b128 v3, v[24:27] offset:8832
  ds_write_b128 v3, v[28:31] offset:13248
  s_mov_b64 exec, s[90:91]
L_exp2_69:
  s_waitcnt lgkmcnt(0)
  s_setprio 0
  s_cmp_lg_u32 s6, 0
  s_cbranch_scc1 L_nopoll_71
  s_lshl_b32 s56, s4, 10
  s_add_u32 s56, s56, 200704
  v_and_b32 v2, 31, v0
  v_lshlrev_b32 v2, 2, v2
  v_add_u32 v2, s56, v2
  s_mov_b32 s82, 0
L_poll_B0_72:
  buffer_load_dword v3, v2, s[16:19], 0 offen sc1
  s_add_u32 s82, s82, 1
  s_waitcnt vmcnt(0)
  v_cmp_ne_u32 s[80:81], s92, v3
  s_nop 1
  s_and_b32 s80, s80, 0xffffffff
  s_and_b32 s81, s81, 0x0
  s_cmp_eq_u64 s[80:81], 0
  s_cbranch_scc1 L_pollout_B0_73
  s_cmp_gt_u32 s82, 20000
  s_cbranch_scc1 L_pollout_B0_73
  s_sleep 4
  s_branch L_poll_B0_72
L_pollout_B0_73:
L_nopoll_71:
  s_barrier
  s_lshl_b32 s7, s6, 6
  v_add_u32 v2, s7, v0
  v_mul_u32_u24 v3, 423, v2
  v_lshrrev_b32 v3, 16, v3
  v_mul_u32_u24 v4, 5120, v3
  v_lshl_add_u32 v4, v2, 4, v4
  v_add_u32 v4, 53248, v4
  v_mov_b32 v8, 0
  v_mov_b32 v9, 0
  v_mov_b32 v10, 0
  v_mov_b32 v11, 0
  v_cmp_gt_u32 vcc, 465, v2
  s_and_saveexec_b64 s[90:91], vcc
  ds_write_b128 v4, v[8:11]
  s_mov_b64 exec, s[90:91]
  s_mov_b32 s58, s6
  s_mul_i32 s88, s58, 13108
  s_lshr_b32 s88, s88, 16
  s_mul_i32 s57, s88, 5
  s_sub_u32 s57, s58, s57
  s_cmp_eq_u32 s88, 2
  s_cbranch_scc1 L_cs_75
  s_mul_i32 s83, s84, 3
  s_add_u32 s83, s83, s89
  s_add_u32 s83, s83, s88
  s_branch L_cs_76
L_cs_75:
  s_add_u32 s83, s89, 2
L_cs_76:
  s_lshl_b32 s56, s57, 6
  v_add_u32 v2, s56, v0
  v_mul_u32_u24 v3, 13108, v2
  v_lshrrev_b32 v3, 16, v3
  v_mul_u32_u24 v4, 5, v3
  v_sub_u32 v4, v2, v4
  v_and_b32 v4, 3, v4
  v_lshlrev_b32 v3, 6, v3
  v_lshl_add_u32 v3, v4, 4, v3
  s_lshl_b32 s56, s83, 12
  s_add_u32 s56, s56, 262144
  s_mul_i32 s7, s88, 7600
  s_lshl_b32 s57, s57, 10
  s_add_u32 s7, s7, s57
  s_add_u32 m0, s7, 55728
  s_nop 0
  buffer_load_dwordx4 v3, s[16:19], s56 offen sc1 lds
  s_cmp_ge_u32 s6, 7
  s_cbranch_scc1 L_ut2_77
  s_add_u32 s58, s6, 8
  s_mul_i32 s88, s58, 13108
  s_lshr_b32 s88, s88, 16
  s_mul_i32 s57, s88, 5
  s_sub_u32 s57, s58, s57
  s_cmp_eq_u32 s88, 2
  s_cbranch_scc1 L_cs_78
  s_mul_i32 s83, s84, 3
  s_add_u32 s83, s83, s89
  s_add_u32 s83, s83, s88
  s_branch L_cs_79
L_cs_78:
  s_add_u32 s83, s89, 2
L_cs_79:
  s_lshl_b32 s56, s57, 6
  v_add_u32 v2, s56, v0
  v_mul_u32_u24 v3, 13108, v2
  v_lshrrev_b32 v3, 16, v3
  v_mul_u32_u24 v4, 5, v3
  v_sub_u32 v4, v2, v4
  v_and_b32 v4, 3, v4
  v_lshlrev_b32 v3, 6, v3
  v_lshl_add_u32 v3, v4, 4, v3
  s_lshl_b32 s56, s83, 12
  s_add_u32 s56, s56, 262144
  s_mul_i32 s7, s88, 7600
  s_lshl_b32 s57, s57, 10
  s_add_u32 s7, s7, s57
  s_add_u32 m0, s7, 55728
  s_nop 0
  buffer_load_dwordx4 v3, s[16:19], s56 offen sc1 lds
L_ut2_77:
  s_waitcnt vmcnt(0) lgkmcnt(0)
  s_barrier
  s_cmp_ge_u32 s6, 6
  s_cbranch_scc1 L_cv6_80
  s_cmp_ge_u32 s6, 3
  s_cselect_b32 s88, 1, 0
  s_mul_i32 s7, s88, 3
  s_sub_u32 s87, s6, s7
  s_branch L_cvd_81
L_cv6_80:
  s_mov_b32 s88, 2
  s_sub_u32 s7, s6, 5
  s_cmp_eq_u32 s6, 6
  s_cselect_b32 s56, 0, 3
  s_cmp_eq_u32 s84, 0
  s_cselect_b32 s87, s7, s56
L_cvd_81:
  s_cmp_eq_u32 s87, 3
  s_cbranch_scc1 L_cv_idle_82
  v_and_b32 v2, 31, v0
  v_lshrrev_b32 v3, 5, v0
  v_sub_u32 v4, 3, v2
  v_and_b32 v4, 3, v4
  s_cmp_eq_u32 s87, 2
  s_cselect_b32 s7, 32, 0
  s_add_u32 s7, s7, 31
  s_lshl_b32 s7, s7, 5
  s_sub_u32 s7, 2047, s7
  v_sub_u32 v5, s7, v2
  v_lshl_add_u32 v5, v3, 3, v5
  v_sub_u32 v5, v5, v4
  v_lshlrev_b32 v5, 1, v5
  v_mul_u32_u24 v4, 4416, v4
  v_add_u32 v5, v5, v4
  s_mul_i32 s7, s88, 17664
  v_add_u32 v5, s7, v5
  s_cmp_eq_u32 s87, 1
  s_cselect_b32 s7, 32, 0
  v_add_u32 v6, s7, v2
  v_mul_u32_u24 v6, 80, v6
  v_lshl_add_u32 v6, v3, 4, v6
  s_mul_i32 s7, s88, 7600
  s_add_u32 s7, s7, 53248
  v_add_u32 v6, s7, v6
  ds_read_b64 v[32:33], v5 offset:1984
  ds_read_b64 v[34:35], v5 offset:1992
  ds_read_b128 v[36:39], v6 offset:2480
  ds_read_b64 v[40:41], v5 offset:2016
  ds_read_b64 v[42:43], v5 offset:2024
  ds_read_b128 v[44:47], v6 offset:2512
  ds_read_b64 v[48:49], v5 offset:1920
  ds_read_b64 v[50:51], v5 offset:1928
  ds_read_b128 v[52:55], v6 offset:2400
  ds_read_b64 v[56:57], v5 offset:1952
  ds_read_b64 v[58:59], v5 offset:1960
  ds_read_b128 v[60:63], v6 offset:2432
  s_waitcnt lgkmcnt(9)
  v_mfma_f32_32x32x16_bf16 v[16:31], v[32:35], v[36:39], 0
  ds_read_b64 v[32:33], v5 offset:1856
  ds_read_b64 v[34:35], v5 offset:1864
  ds_read_b128 v[36:39], v6 offset:2320
  s_waitcnt lgkmcnt(9)
  v_mfma_f32_32x32x16_bf16 v[16:31], v[40:43], v[44:47], v[16:31]
  ds_read_b64 v[40:41], v5 offset:1888
  ds_read_b64 v[42:43], v5 offset:1896
  ds_read_b128 v[44:47], v6 offset:2352
  s_waitcnt lgkmcnt(9)
  v_mfma_f32_32x32x16_bf16 v[16:31], v[48:51], v[52:55], v[16:31]
  ds_read_b64 v[48:49], v5 offset:1792
  ds_read_b64 v[50:51], v5 offset:1800
  ds_read_b128 v[52:55], v6 offset:2240
  s_waitcnt lgkmcnt(9)
  v_mfma_f32_32x32x16_bf16 v[16:31], v[56:59], v[60:63], v[16:31]
  ds_read_b64 v[56:57], v5 offset:1824
  ds_read_b64 v[58:59], v5 offset:1832
  ds_read_b128 v[60:63], v6 offset:2272
  s_waitcnt lgkmcnt(9)
  v_mfma_f32_32x32x16_bf16 v[16:31], v[32:35], v[36:39], v[16:31]
  ds_read_b64 v[32:33], v5 offset:1728
  ds_read_b64 v[34:35], v5 offset:1736
  ds_read_b128 v[36:39], v6 offset:2160
  s_waitcnt lgkmcnt(9)
  v_mfma_f32_32x32x16_bf16 v[16:31], v[40:43], v[44:47], v[16:31]
  ds_read_b64 v[40:41], v5 offset:1760
  ds_read_b64 v[42:43], v5 offset:1768
  ds_read_b128 v[44:47], v6 offset:2192
  s_waitcnt lgkmcnt(9)
  v_mfma_f32_32x32x16_bf16 v[16:31], v[48:51], v[52:55], v[16:31]
  ds_read_b64 v[48:49], v5 offset:1664
  ds_read_b64 v[50:51], v5 offset:1672
  ds_read_b128 v[52:55], v6 offset:2080
  s_waitcnt lgkmcnt(9)
  v_mfma_f32_32x32x16_bf16 v[16:31], v[56:59], v[60:63], v[16:31]
  ds_read_b64 v[56:57], v5 offset:1696
  ds_read_b64 v[58:59], v5 offset:1704
  ds_read_b128 v[60:63], v6 offset:2112
  s_waitcnt lgkmcnt(9)
  v_mfma_f32_32x32x16_bf16 v[16:31], v[32:35], v[36:39], v[16:31]
  ds_read_b64 v[32:33], v5 offset:1600
  ds_read_b64 v[34:35], v5 offset:1608
  ds_read_b128 v[36:39], v6 offset:2000
  s_waitcnt lgkmcnt(9)
  v_mfma_f32_32x32x16_bf16 v[16:31], v[40:43], v[44:47], v[16:31]
  ds_read_b64 v[40:41], v5 offset:1632
  ds_read_b64 v[42:43], v5 offset:1640
  ds_read_b128 v[44:47], v6 offset:2032
  s_waitcnt lgkmcnt(9)
  v_mfma_f32_32x32x16_bf16 v[16:31], v[48:51], v[52:55], v[16:31]
  ds_read_b64 v[48:49], v5 offset:1536
  ds_read_b64 v[50:51], v5 offset:1544
  ds_read_b128 v[52:55], v6 offset:1920
  s_waitcnt lgkmcnt(9)
  v_mfma_f32_32x32x16_bf16 v[16:31], v[56:59], v[60:63], v[16:31]
  ds_read_b64 v[56:57], v5 offset:1568
  ds_read_b64 v[58:59], v5 offset:1576
  ds_read_b128 v[60:63], v6 offset:1952
  s_waitcnt lgkmcnt(9)
  v_mfma_f32_32x32x16_bf16 v[16:31], v[32:35], v[36:39], v[16:31]
  ds_read_b64 v[32:33], v5 offset:1472
  ds_read_b64 v[34:35], v5 offset:1480
  ds_read_b128 v[36:39], v6 offset:1840
  s_waitcnt lgkmcnt(9)
  v_mfma_f32_32x32x16_bf16 v[16:31], v[40:43], v[44:47], v[16:31]
  ds_read_b64 v[40:41], v5 offset:1504
  ds_read_b64 v[42:43], v5 offset:1512
  ds_read_b128 v[44:47], v6 offset:1872
  s_waitcnt lgkmcnt(9)
  v_mfma_f32_32x32x16_bf16 v[16:31], v[48:51], v[52:55], v[16:31]
  ds_read_b64 v[48:49], v5 offset:1408
  ds_read_b64 v[50:51], v5 offset:1416
  ds_read_b128 v[52:55], v6 offset:1760
  s_waitcnt lgkmcnt(9)
  v_mfma_f32_32x32x16_bf16 v[16:31], v[56:59], v[60:63], v[16:31]
  ds_read_b64 v[56:57], v5 offset:1440
  ds_read_b64 v[58:59], v5 offset:1448
  ds_read_b128 v[60:63], v6 offset:1792
  s_waitcnt lgkmcnt(9)
  v_mfma_f32_32x32x16_bf16 v[16:31], v[32:35], v[36:39], v[16:31]
  ds_read_b64 v[32:33], v5 offset:1344
  ds_read_b64 v[34:35], v5 offset:1352
  ds_read_b128 v[36:39], v6 offset:1680
  s_waitcnt lgkmcnt(9)
  v_mfma_f32_32x32x16_bf16 v[16:31], v[40:43], v[44:47], v[16:31]
  ds_read_b64 v[40:41], v5 offset:1376
  ds_read_b64 v[42:43], v5 offset:1384
  ds_read_b128 v[44:47], v6 offset:1712
  s_waitcnt lgkmcnt(9)
  v_mfma_f32_32x32x16_bf16 v[16:31], v[48:51], v[52:55], v[16:31]
  ds_read_b64 v[48:49], v5 offset:1280
  ds_read_b64 v[50:51], v5 offset:1288
  ds_read_b128 v[52:55], v6 offset:1600
  s_waitcnt lgkmcnt(9)
  v_mfma_f32_32x32x16_bf16 v[16:31], v[56:59], v[60:63], v[16:31]
  ds_read_b64 v[56:57], v5 offset:1312
  ds_read_b64 v[58:59], v5 offset:1320
  ds_read_b128 v[60:63], v6 offset:1632
  s_waitcnt lgkmcnt(9)
  v_mfma_f32_32x32x16_bf16 v[16:31], v[32:35], v[36:39], v[16:31]
  ds_read_b64 v[32:33], v5 offset:1216
  ds_read_b64 v[34:35], v5 offset:1224
  ds_read_b128 v[36:39], v6 offset:1520
  s_waitcnt lgkmcnt(9)
  v_mfma_f32_32x32x16_bf16 v[16:31], v[40:43], v[44:47], v[16:31]
  ds_read_b64 v[40:41], v5 offset:1248
  ds_read_b64 v[42:43], v5 offset:1256
  ds_read_b128 v[44:47], v6 offset:1552
  s_waitcnt lgkmcnt(9)
  v_mfma_f32_32x32x16_bf16 v[16:31], v[48:51], v[52:55], v[16:31]
  ds_read_b64 v[48:49], v5 offset:1152
  ds_read_b64 v[50:51], v5 offset:1160
  ds_read_b128 v[52:55], v6 offset:1440
  s_waitcnt lgkmcnt(9)
  v_mfma_f32_32x32x16_bf16 v[16:31], v[56:59], v[60:63], v[16:31]
  ds_read_b64 v[56:57], v5 offset:1184
  ds_read_b64 v[58:59], v5 offset:1192
  ds_read_b128 v[60:63], v6 offset:1472
  s_waitcnt lgkmcnt(9)
  v_mfma_f32_32x32x16_bf16 v[16:31], v[32:35], v[36:39], v[16:31]
  ds_read_b64 v[32:33], v5 offset:1088
  ds_read_b64 v[34:35], v5 offset:1096
  ds_read_b128 v[36:39], v6 offset:1360
  s_waitcnt lgkmcnt(9)
  v_mfma_f32_32x32x16_bf16 v[16:31], v[40:43], v[44:47], v[16:31]
  ds_read_b64 v[40:41], v5 offset:1120
  ds_read_b64 v[42:43], v5 offset:1128
  ds_read_b128 v[44:47], v6 offset:1392
  s_waitcnt lgkmcnt(9)
  v_mfma_f32_32x32x16_bf16 v[16:31], v[48:51], v[52:55], v[16:31]
  ds_read_b64 v[48:49], v5 offset:1024
  ds_read_b64 v[50:51], v5 offset:1032
  ds_read_b128 v[52:55], v6 offset:1280
  s_waitcnt lgkmcnt(9)
  v_mfma_f32_32x32x16_bf16 v[16:31], v[56:59], v[60:63], v[16:31]
  ds_read_b64 v[56:57], v5 offset:1056
  ds_read_b64 v[58:59], v5 offset:1064
  ds_read_b128 v[60:63], v6 offset:1312
  s_waitcnt lgkmcnt(9)
  v_mfma_f32_32x32x16_bf16 v[16:31], v[32:35], v[36:39], v[16:31]
  ds_read_b64 v[32:33], v5 offset:960
  ds_read_b64 v[34:35], v5 offset:968
  ds_read_b128 v[36:39], v6 offset:1200
  s_waitcnt lgkmcnt(9)
  v_mfma_f32_32x32x16_bf16 v[16:31], v[40:43], v[44:47], v[16:31]
  ds_read_b64 v[40:41], v5 offset:992
  ds_read_b64 v[42:43], v5 offset:1000
  ds_read_b128 v[44:47], v6 offset:1232
  s_waitcnt lgkmcnt(9)
  v_mfma_f32_32x32x16_bf16 v[16:31], v[48:51], v[52:55], v[16:31]
  ds_read_b64 v[48:49], v5 offset:896
  ds_read_b64 v[50:51], v5 offset:904
  ds_read_b128 v[52:55], v6 offset:1120
  s_waitcnt lgkmcnt(9)
  v_mfma_f32_32x32x16_bf16 v[16:31], v[56:59], v[60:63], v[16:31]
  ds_read_b64 v[56:57], v5 offset:928
  ds_read_b64 v[58:59], v5 offset:936
  ds_read_b128 v[60:63], v6 offset:1152
  s_waitcnt lgkmcnt(9)
  v_mfma_f32_32x32x16_bf16 v[16:31], v[32:35], v[36:39], v[16:31]
  ds_read_b64 v[32:33], v5 offset:832
  ds_read_b64 v[34:35], v5 offset:840
  ds_read_b128 v[36:39], v6 offset:1040
  s_waitcnt lgkmcnt(9)
  v_mfma_f32_32x32x16_bf16 v[16:31], v[40:43], v[44:47], v[16:31]
  ds_read_b64 v[40:41], v5 offset:864
  ds_read_b64 v[42:43], v5 offset:872
  ds_read_b128 v[44:47], v6 offset:1072
  s_waitcnt lgkmcnt(9)
  v_mfma_f32_32x32x16_bf16 v[16:31], v[48:51], v[52:55], v[16:31]
  ds_read_b64 v[48:49], v5 offset:768
  ds_read_b64 v[50:51], v5 offset:776
  ds_read_b128 v[52:55], v6 offset:960
  s_waitcnt lgkmcnt(9)
  v_mfma_f32_32x32x16_bf16 v[16:31], v[56:59], v[60:63], v[16:31]
  ds_read_b64 v[56:57], v5 offset:800
  ds_read_b64 v[58:59], v5 offset:808
  ds_read_b128 v[60:63], v6 offset:992
  s_waitcnt lgkmcnt(9)
  v_mfma_f32_32x32x16_bf16 v[16:31], v[32:35], v[36:39], v[16:31]
  ds_read_b64 v[32:33], v5 offset:704
  ds_read_b64 v[34:35], v5 offset:712
  ds_read_b128 v[36:39], v6 offset:880
  s_waitcnt lgkmcnt(9)
  v_mfma_f32_32x32x16_bf16 v[16:31], v[40:43], v[44:47], v[16:31]
  ds_read_b64 v[40:41], v5 offset:736
  ds_read_b64 v[42:43], v5 offset:744
  ds_read_b128 v[44:47], v6 offset:912
  s_waitcnt lgkmcnt(9)
  v_mfma_f32_32x32x16_bf16 v[16:31], v[48:51], v[52:55], v[16:31]
  ds_read_b64 v[48:49], v5 offset:640
  ds_read_b64 v[50:51], v5 offset:648
  ds_read_b128 v[52:55], v6 offset:800
  s_waitcnt lgkmcnt(9)
  v_mfma_f32_32x32x16_bf16 v[16:31], v[56:59], v[60:63], v[16:31]
  ds_read_b64 v[56:57], v5 offset:672
  ds_read_b64 v[58:59], v5 offset:680
  ds_read_b128 v[60:63], v6 offset:832
  s_waitcnt lgkmcnt(9)
  v_mfma_f32_32x32x16_bf16 v[16:31], v[32:35], v[36:39], v[16:31]
  ds_read_b64 v[32:33], v5 offset:576
  ds_read_b64 v[34:35], v5 offset:584
  ds_read_b128 v[36:39], v6 offset:720
  s_waitcnt lgkmcnt(9)
  v_mfma_f32_32x32x16_bf16 v[16:31], v[40:43], v[44:47], v[16:31]
  ds_read_b64 v[40:41], v5 offset:608
  ds_read_b64 v[42:43], v5 offset:616
  ds_read_b128 v[44:47], v6 offset:752
  s_waitcnt lgkmcnt(9)
  v_mfma_f32_32x32x16_bf16 v[16:31], v[48:51], v[52:55], v[16:31]
  ds_read_b64 v[48:49], v5 offset:512
  ds_read_b64 v[50:51], v5 offset:520
  ds_read_b128 v[52:55], v6 offset:640
  s_waitcnt lgkmcnt(9)
  v_mfma_f32_32x32x16_bf16 v[16:31], v[56:59], v[60:63], v[16:31]
  ds_read_b64 v[56:57], v5 offset:544
  ds_read_b64 v[58:59], v5 offset:552
  ds_read_b128 v[60:63], v6 offset:672
  s_waitcnt lgkmcnt(9)
  v_mfma_f32_32x32x16_bf16 v[16:31], v[32:35], v[36:39], v[16:31]
  ds_read_b64 v[32:33], v5 offset:448
  ds_read_b64 v[34:35], v5 offset:456
  ds_read_b128 v[36:39], v6 offset:560
  s_waitcnt lgkmcnt(9)
  v_mfma_f32_32x32x16_bf16 v[16:31], v[40:43], v[44:47], v[16:31]
  ds_read_b64 v[40:41], v5 offset:480
  ds_read_b64 v[42:43], v5 offset:488
  ds_read_b128 v[44:47], v6 offset:592
  s_waitcnt lgkmcnt(9)
  v_mfma_f32_32x32x16_bf16 v[16:31], v[48:51], v[52:55], v[16:31]
  ds_read_b64 v[48:49], v5 offset:384
  ds_read_b64 v[50:51], v5 offset:392
  ds_read_b128 v[52:55], v6 offset:480
  s_waitcnt lgkmcnt(9)
  v_mfma_f32_32x32x16_bf16 v[16:31], v[56:59], v[60:63], v[16:31]
  ds_read_b64 v[56:57], v5 offset:416
  ds_read_b64 v[58:59], v5 offset:424
  ds_read_b128 v[60:63], v6 offset:512
  s_waitcnt lgkmcnt(9)
  v_mfma_f32_32x32x16_bf16 v[16:31], v[32:35], v[36:39], v[16:31]
  ds_read_b64 v[32:33], v5 offset:320
  ds_read_b64 v[34:35], v5 offset:328
  ds_read_b128 v[36:39], v6 offset:400
  s_waitcnt lgkmcnt(9)
  v_mfma_f32_32x32x16_bf16 v[16:31], v[40:43], v[44:47], v[16:31]
  ds_read_b64 v[40:41], v5 offset:352
  ds_read_b64 v[42:43], v5 offset:360
  ds_read_b128 v[44:47], v6 offset:432
  s_waitcnt lgkmcnt(9)
  v_mfma_f32_32x32x16_bf16 v[16:31], v[48:51], v[52:55], v[16:31]
  ds_read_b64 v[48:49], v5 offset:256
  ds_read_b64 v[50:51], v5 offset:264
  ds_read_b128 v[52:55], v6 offset:320
  s_waitcnt lgkmcnt(9)
  v_mfma_f32_32x32x16_bf16 v[16:31], v[56:59], v[60:63], v[16:31]
  ds_read_b64 v[56:57], v5 offset:288
  ds_read_b64 v[58:59], v5 offset:296
  ds_read_b128 v[60:63], v6 offset:352
  s_waitcnt lgkmcnt(9)
  v_mfma_f32_32x32x16_bf16 v[16:31], v[32:35], v[36:39], v[16:31]
  ds_read_b64 v[32:33], v5 offset:192
  ds_read_b64 v[34:35], v5 offset:200
  ds_read_b128 v[36:39], v6 offset:240
  s_waitcnt lgkmcnt(9)
  v_mfma_f32_32x32x16_bf16 v[16:31], v[40:43], v[44:47], v[16:31]
  ds_read_b64 v[40:41], v5 offset:224
  ds_read_b64 v[42:43], v5 offset:232
  ds_read_b128 v[44:47], v6 offset:272
  s_waitcnt lgkmcnt(9)
  v_mfma_f32_32x32x16_bf16 v[16:31], v[48:51], v[52:55], v[16:31]
  ds_read_b64 v[48:49], v5 offset:128
  ds_read_b64 v[50:51], v5 offset:136
  ds_read_b128 v[52:55], v6 offset:160
  s_waitcnt lgkmcnt(9)
  v_mfma_f32_32x32x16_bf16 v[16:31], v[56:59], v[60:63], v[16:31]
  ds_read_b64 v[56:57], v5 offset:160
  ds_read_b64 v[58:59], v5 offset:168
  ds_read_b128 v[60:63], v6 offset:192
  s_waitcnt lgkmcnt(9)
  v_mfma_f32_32x32x16_bf16 v[16:31], v[32:35], v[36:39], v[16:31]
  ds_read_b64 v[32:33], v5 offset:64
  ds_read_b64 v[34:35], v5 offset:72
  ds_read_b128 v[36:39], v6 offset:80
  s_waitcnt lgkmcnt(9)
  v_mfma_f32_32x32x16_bf16 v[16:31], v[40:43], v[44:47], v[16:31]
  ds_read_b64 v[40:41], v5 offset:96
  ds_read_b64 v[42:43], v5 offset:104
  ds_read_b128 v[44:47], v6 offset:112
  s_waitcnt lgkmcnt(9)
  v_mfma_f32_32x32x16_bf16 v[16:31], v[48:51], v[52:55], v[16:31]
  ds_read_b64 v[48:49], v5 offset:0
  ds_read_b64 v[50:51], v5 offset:8
  ds_read_b128 v[52:55], v6 offset:0
  s_waitcnt lgkmcnt(9)
  v_mfma_f32_32x32x16_bf16 v[16:31], v[56:59], v[60:63], v[16:31]
  ds_read_b64 v[56:57], v5 offset:32
  ds_read_b64 v[58:59], v5 offset:40
  ds_read_b128 v[60:63], v6 offset:32
  s_waitcnt lgkmcnt(9)
  v_mfma_f32_32x32x16_bf16 v[16:31], v[32:35], v[36:39], v[16:31]
  s_waitcnt lgkmcnt(6)
  v_mfma_f32_32x32x16_bf16 v[16:31], v[40:43], v[44:47], v[16:31]
  s_waitcnt lgkmcnt(3)
  v_mfma_f32_32x32x16_bf16 v[16:31], v[48:51], v[52:55], v[16:31]
  s_waitcnt lgkmcnt(0)
  v_mfma_f32_32x32x16_bf16 v[16:31], v[56:59], v[60:63], v[16:31]
  s_nop 13
L_cv_idle_82:
  s_setprio 2
  s_barrier
  v_lshlrev_b32 v2, 4, v0
  s_lshl_b32 s7, s88, 12
  v_add_u32 v2, s7, v2
  s_cmp_lg_u32 s87, 2
  s_cbranch_scc1 L_cv_n2_83
  ds_write_b128 v2, v[16:19] offset:0
  ds_write_b128 v2, v[20:23] offset:1024
  ds_write_b128 v2, v[24:27] offset:2048
  ds_write_b128 v2, v[28:31] offset:3072
  s_waitcnt lgkmcnt(0)
L_cv_n2_83:
  s_barrier
  s_cmp_ge_u32 s87, 2
  s_cbranch_scc1 L_cv_fin_84
  s_cmp_eq_u32 s87, 0
  s_cbranch_scc1 L_cv_noadd_85
  ds_read_b128 v[32:35], v2 offset:0
  ds_read_b128 v[36:39], v2 offset:1024
  ds_read_b128 v[40:43], v2 offset:2048
  ds_read_b128 v[44:47], v2 offset:3072
  s_waitcnt lgkmcnt(0)
  v_add_f32 v16, v16, v32
  v_add_f32 v17, v17, v33
  v_add_f32 v18, v18, v34
  v_add_f32 v19, v19, v35
  v_add_f32 v20, v20, v36
  v_add_f32 v21, v21, v37
  v_add_f32 v22, v22, v38
  v_add_f32 v23, v23, v39
  v_add_f32 v24, v24, v40
  v_add_f32 v25, v25, v41
  v_add_f32 v26, v26, v42
  v_add_f32 v27, v27, v43
  v_add_f32 v28, v28, v44
  v_add_f32 v29, v29, v45
  v_add_f32 v30, v30, v46
  v_add_f32 v31, v31, v47
L_cv_noadd_85:
  v_cvt_pk_bf16_f32 v32, v16, v17
  v_cvt_pk_bf16_f32 v33, v18, v19
  v_cvt_pk_bf16_f32 v34, v20, v21
  v_cvt_pk_bf16_f32 v35, v22, v23
  v_cvt_pk_bf16_f32 v36, v24, v25
  v_cvt_pk_bf16_f32 v37, v26, v27
  v_cvt_pk_bf16_f32 v38, v28, v29
  v_cvt_pk_bf16_f32 v39, v30, v31
  v_and_b32 v3, 31, v0
  v_lshlrev_b32 v3, 6, v3
  v_lshrrev_b32 v4, 5, v0
  v_lshl_add_u32 v3, v4, 3, v3
  s_lshl_b32 s7, s6, 11
  s_add_u32 s7, s7, 16384
  v_add_u32 v3, s7, v3
  ds_write_b64 v3, v[32:33] offset:0
  ds_write_b64 v3, v[34:35] offset:16
  ds_write_b64 v3, v[36:37] offset:32
  ds_write_b64 v3, v[38:39] offset:48
  v_lshlrev_b32 v4, 4, v0
  v_add_u32 v5, s7, v4
  s_waitcnt lgkmcnt(0)
  ds_read_b128 v[40:43], v5
  ds_read_b128 v[44:47], v5 offset:1024
  s_cmp_eq_u32 s88, 2
  s_cbranch_scc1 L_cs_86
  s_mul_i32 s83, s84, 3
  s_add_u32 s83, s83, s89
  s_add_u32 s83, s83, s88
  s_branch L_cs_87
L_cs_86:
  s_add_u32 s83, s89, 2
L_cs_87:
  s_lshl_b32 s56, s83, 12
  s_lshl_b32 s57, s87, 11
  s_add_u32 s56, s56, s57
  s_add_u32 s56, s56, 2883584
  s_waitcnt lgkmcnt(1)
  buffer_store_dwordx4 v[40:43], v4, s[16:19], s56 offen sc1
  s_waitcnt lgkmcnt(0)
  buffer_store_dwordx4 v[44:47], v4, s[16:19], s56 offen offset:1024 sc1
L_cv_fin_84:
  s_waitcnt vmcnt(0)
  s_barrier
  s_lshl_b32 s56, s4, 10
  s_lshl_b32 s7, s5, 2
  s_add_u32 s56, s56, s7
  s_add_u32 s56, s56, 208896
  s_cmp_lg_u32 s6, 0
  s_cbranch_scc1 L_garr_88
  v_mov_b32 v2, 0
  v_mov_b32 v3, s92
  s_mov_b64 exec, 0x1
  buffer_store_dword v3, v2, s[16:19], s56 offen sc1
  s_mov_b64 exec, -1
L_garr_88:
  s_barrier
  s_mul_i32 s56, s6, 20480
  s_mul_i32 s57, s86, 160
  s_add_u32 s56, s56, s57
  v_add_u32 v20, 0, v0
  v_mul_u32_u24 v21, 6554, v20
  v_lshrrev_b32 v21, 16, v21
  v_mul_u32_u24 v21, 1120, v21
  v_lshl_add_u32 v21, v20, 4, v21
  v_add_u32 v2, s56, v21
  v_add_u32 v20, 64, v0
  v_mul_u32_u24 v21, 6554, v20
  v_lshrrev_b32 v21, 16, v21
  v_mul_u32_u24 v21, 1120, v21
  v_lshl_add_u32 v21, v20, 4, v21
  v_add_u32 v3, s56, v21
  v_add_u32 v20, 128, v0
  v_mul_u32_u24 v21, 6554, v20
  v_lshrrev_b32 v21, 16, v21
  v_mul_u32_u24 v21, 1120, v21
  v_lshl_add_u32 v21, v20, 4, v21
  v_add_u32 v4, s56, v21
  s_mov_b32 s57, 655360
  s_mul_i32 s58, s6, 2560
  s_add_u32 m0, s58, 0
  s_nop 0
  buffer_load_dwordx4 v2, s[48:51], s57 offen lds
  s_add_u32 m0, s58, 1024
  s_nop 0
  buffer_load_dwordx4 v3, s[48:51], s57 offen lds
  s_add_u32 m0, s58, 2048
  s_mov_b32 exec_hi, 0
  buffer_load_dwordx4 v4, s[48:51], s57 offen lds
  s_mov_b32 exec_hi, -1
  v_lshrrev_b32 v5, 4, v0
  v_lshlrev_b32 v5, 3, v5
  v_bfe_u32 v6, v0, 2, 2
  v_add_u32 v5, v5, v6
  v_mul_u32_u24 v5, 160, v5
  v_and_b32 v6, 3, v0
  v_lshl_add_u32 v5, v6, 3, v5
  s_lshr_b32 s88, s6, 2
  s_and_b32 s87, s6, 3
  s_mul_i32 s7, s88, 10240
  v_add_u32 v6, s7, v5
  s_waitcnt vmcnt(0)
  s_barrier
  ds_read_b64_tr_b16 v[88:89], v6 offset:0
  ds_read_b64_tr_b16 v[90:91], v6 offset:640
  ds_read_b64_tr_b16 v[92:93], v6 offset:32
  ds_read_b64_tr_b16 v[94:95], v6 offset:672
  ds_read_b64_tr_b16 v[96:97], v6 offset:64
  ds_read_b64_tr_b16 v[98:99], v6 offset:704
  ds_read_b64_tr_b16 v[100:101], v6 offset:96
  ds_read_b64_tr_b16 v[102:103], v6 offset:736
  ds_read_b64_tr_b16 v[104:105], v6 offset:128
  ds_read_b64_tr_b16 v[106:107], v6 offset:768
  s_waitcnt lgkmcnt(0)
  ds_read_b64_tr_b16 v[108:109], v6 offset:5120
  ds_read_b64_tr_b16 v[110:111], v6 offset:5760
  ds_read_b64_tr_b16 v[112:113], v6 offset:5152
  ds_read_b64_tr_b16 v[114:115], v6 offset:5792
  ds_read_b64_tr_b16 v[116:117], v6 offset:5184
  ds_read_b64_tr_b16 v[118:119], v6 offset:5824
  ds_read_b64_tr_b16 v[120:121], v6 offset:5216
  ds_read_b64_tr_b16 v[122:123], v6 offset:5856
  ds_read_b64_tr_b16 v[124:125], v6 offset:5248
  ds_read_b64_tr_b16 v[126:127], v6 offset:5888
  s_waitcnt lgkmcnt(0)
  s_barrier
  s_mov_b32 s57, 0
  s_mul_i32 s58, s6, 2560
  s_add_u32 m0, s58, 0
  s_nop 0
  buffer_load_dwordx4 v2, s[48:51], s57 offen lds
  s_add_u32 m0, s58, 1024
  s_nop 0
  buffer_load_dwordx4 v3, s[48:51], s57 offen lds
  s_add_u32 m0, s58, 2048
  s_mov_b32 exec_hi, 0
  buffer_load_dwordx4 v4, s[48:51], s57 offen lds
  s_mov_b32 exec_hi, -1
  s_mov_b32 s57, 163840
  s_mul_i32 s58, s6, 2560
  s_add_u32 m0, s58, 20480
  s_nop 0
  buffer_load_dwordx4 v2, s[48:51], s57 offen lds
  s_add_u32 m0, s58, 21504
  s_nop 0
  buffer_load_dwordx4 v3, s[48:51], s57 offen lds
  s_add_u32 m0, s58, 22528
  s_mov_b32 exec_hi, 0
  buffer_load_dwordx4 v4, s[48:51], s57 offen lds
  s_mov_b32 exec_hi, -1
  s_mov_b32 s57, 327680
  s_mul_i32 s58, s6, 2560
  s_add_u32 m0, s58, 40960
  s_nop 0
  buffer_load_dwordx4 v2, s[48:51], s57 offen lds
  s_add_u32 m0, s58, 41984
  s_nop 0
  buffer_load_dwordx4 v3, s[48:51], s57 offen lds
  s_add_u32 m0, s58, 43008
  s_mov_b32 exec_hi, 0
  buffer_load_dwordx4 v4, s[48:51], s57 offen lds
  s_mov_b32 exec_hi, -1
  s_mov_b32 s57, 491520
  s_mul_i32 s58, s6, 2560
  s_add_u32 m0, s58, 61440
  s_nop 0
  buffer_load_dwordx4 v2, s[48:51], s57 offen lds
  s_add_u32 m0, s58, 62464
  s_nop 0
  buffer_load_dwordx4 v3, s[48:51], s57 offen lds
  s_add_u32 m0, s58, 63488
  s_mov_b32 exec_hi, 0
  buffer_load_dwordx4 v4, s[48:51], s57 offen lds
  s_mov_b32 exec_hi, -1
  s_mul_i32 s7, s88, 40960
  v_add_u32 v6, s7, v5
  v_lshlrev_b32 v7, 4, v0
  s_mul_i32 s57, s85, 81920
  s_mul_i32 s58, s87, 20480
  s_add_u32 s57, s57, s58
  s_add_u32 s57, s57, 5505024
  s_lshl_b32 s58, s88, 13
  s_add_u32 s83, s57, s58
  s_lshl_b32 s58, s88, 11
  s_add_u32 s89, s57, s58
  s_add_u32 s89, s89, 16384
  s_waitcnt vmcnt(0)
  s_barrier
  ds_read_b64_tr_b16 v[68:69], v6 offset:0
  ds_read_b64_tr_b16 v[70:71], v6 offset:640
  ds_read_b64_tr_b16 v[72:73], v6 offset:32
  ds_read_b64_tr_b16 v[74:75], v6 offset:672
  ds_read_b64_tr_b16 v[76:77], v6 offset:64
  ds_read_b64_tr_b16 v[78:79], v6 offset:704
  ds_read_b64_tr_b16 v[80:81], v6 offset:96
  ds_read_b64_tr_b16 v[82:83], v6 offset:736
  ds_read_b64_tr_b16 v[84:85], v6 offset:128
  ds_read_b64_tr_b16 v[86:87], v6 offset:768
  v_and_b32 v3, 15, v0
  s_lshl_b32 s7, s85, 2
  s_add_u32 s7, s7, s87
  s_lshl_b32 s7, s7, 4
  v_add_u32 v3, s7, v3
  v_mul_u32_u24 v3, 2560, v3
  v_lshrrev_b32 v4, 4, v0
  v_lshl_add_u32 v3, v4, 3, v3
  s_waitcnt lgkmcnt(0)
  s_setprio 3
  s_cmp_lg_u32 s6, 0
  s_cbranch_scc1 L_nopoll_89
  s_lshl_b32 s56, s85, 9
  s_add_u32 s56, s56, 229376
  v_and_b32 v2, 7, v0
  v_lshlrev_b32 v2, 2, v2
  v_add_u32 v2, s56, v2
  s_mov_b32 s82, 0
L_poll_B2_90:
  buffer_load_dword v4, v2, s[16:19], 0 offen sc1
  s_add_u32 s82, s82, 1
  s_waitcnt vmcnt(0)
  v_cmp_ne_u32 s[80:81], s92, v4
  s_nop 1
  s_and_b32 s80, s80, 0xff
  s_and_b32 s81, s81, 0x0
  s_cmp_eq_u64 s[80:81], 0
  s_cbranch_scc1 L_pollout_B2_91
  s_cmp_gt_u32 s82, 20000
  s_cbranch_scc1 L_pollout_B2_91
  s_bcnt1_i32_b64 s80, s[80:81]
  s_cmp_lt_u32 s80, 8
  s_cbranch_scc1 L_pollfast_B2_92
  s_sleep 6
  s_branch L_poll_B2_90
L_pollfast_B2_92:
  s_sleep 4
  s_branch L_poll_B2_90
L_pollout_B2_91:
L_nopoll_89:
  s_barrier
  buffer_load_dwordx4 v[8:11], v7, s[16:19], s89 offen offset:0 sc1
  buffer_load_dwordx4 v[12:15], v7, s[16:19], s89 offen offset:1024 sc1
  buffer_load_dwordx4 v[16:19], v7, s[16:19], s83 offen offset:0 sc1
  buffer_load_dwordx4 v[20:23], v7, s[16:19], s83 offen offset:1024 sc1
  buffer_load_dwordx4 v[24:27], v7, s[16:19], s83 offen offset:2048 sc1
  buffer_load_dwordx4 v[28:31], v7, s[16:19], s83 offen offset:3072 sc1
  s_add_u32 s83, s83, 4096
  buffer_load_dwordx4 v[32:35], v7, s[16:19], s83 offen offset:0 sc1
  buffer_load_dwordx4 v[36:39], v7, s[16:19], s83 offen offset:1024 sc1
  buffer_load_dwordx4 v[40:43], v7, s[16:19], s83 offen offset:2048 sc1
  buffer_load_dwordx4 v[44:47], v7, s[16:19], s83 offen offset:3072 sc1
  s_mul_i32 s7, s6, 3072
  v_add_u32 v2, s7, v7
  s_xor_b32 s7, s6, 4
  s_mul_i32 s7, s7, 3072
  v_add_u32 v4, s7, v7
  s_mul_i32 s57, s86, 160
  s_add_u32 s57, s57, 1280
  s_waitcnt vmcnt(9)
  v_mfma_f32_16x16x32_bf16 v[48:51], v[88:91], v[8:11], 0
  v_mfma_f32_16x16x32_bf16 v[52:55], v[92:95], v[8:11], 0
  v_mfma_f32_16x16x32_bf16 v[56:59], v[96:99], v[8:11], 0
  v_mfma_f32_16x16x32_bf16 v[60:63], v[100:103], v[8:11], 0
  v_mfma_f32_16x16x32_bf16 v[64:67], v[104:107], v[8:11], 0
  s_waitcnt vmcnt(8)
  v_mfma_f32_16x16x32_bf16 v[48:51], v[108:111], v[12:15], v[48:51]
  v_mfma_f32_16x16x32_bf16 v[52:55], v[112:115], v[12:15], v[52:55]
  v_mfma_f32_16x16x32_bf16 v[56:59], v[116:119], v[12:15], v[56:59]
  v_mfma_f32_16x16x32_bf16 v[60:63], v[120:123], v[12:15], v[60:63]
  v_mfma_f32_16x16x32_bf16 v[64:67], v[124:127], v[12:15], v[64:67]
  s_waitcnt vmcnt(7)
  s_waitcnt lgkmcnt(8)
  v_mfma_f32_16x16x32_bf16 v[48:51], v[68:71], v[16:19], v[48:51]
  ds_read_b64_tr_b16 v[68:69], v6 offset:5120
  ds_read_b64_tr_b16 v[70:71], v6 offset:5760
  s_waitcnt lgkmcnt(8)
  v_mfma_f32_16x16x32_bf16 v[52:55], v[72:75], v[16:19], v[52:55]
  ds_read_b64_tr_b16 v[72:73], v6 offset:5152
  ds_read_b64_tr_b16 v[74:75], v6 offset:5792
  s_waitcnt lgkmcnt(8)
  v_mfma_f32_16x16x32_bf16 v[56:59], v[76:79], v[16:19], v[56:59]
  ds_read_b64_tr_b16 v[76:77], v6 offset:5184
  ds_read_b64_tr_b16 v[78:79], v6 offset:5824
  s_waitcnt lgkmcnt(8)
  v_mfma_f32_16x16x32_bf16 v[60:63], v[80:83], v[16:19], v[60:63]
  ds_read_b64_tr_b16 v[80:81], v6 offset:5216
  ds_read_b64_tr_b16 v[82:83], v6 offset:5856
  s_waitcnt lgkmcnt(8)
  v_mfma_f32_16x16x32_bf16 v[64:67], v[84:87], v[16:19], v[64:67]
  s_waitcnt vmcnt(6)
  ds_read_b64_tr_b16 v[84:85], v6 offset:5248
  ds_read_b64_tr_b16 v[86:87], v6 offset:5888
  s_waitcnt lgkmcnt(8)
  v_mfma_f32_16x16x32_bf16 v[48:51], v[68:71], v[20:23], v[48:51]
  ds_read_b64_tr_b16 v[68:69], v6 offset:10240
  ds_read_b64_tr_b16 v[70:71], v6 offset:10880
  s_waitcnt lgkmcnt(8)
  v_mfma_f32_16x16x32_bf16 v[52:55], v[72:75], v[20:23], v[52:55]
  ds_read_b64_tr_b16 v[72:73], v6 offset:10272
  ds_read_b64_tr_b16 v[74:75], v6 offset:10912
  s_waitcnt lgkmcnt(8)
  v_mfma_f32_16x16x32_bf16 v[56:59], v[76:79], v[20:23], v[56:59]
  ds_read_b64_tr_b16 v[76:77], v6 offset:10304
  ds_read_b64_tr_b16 v[78:79], v6 offset:10944
  s_waitcnt lgkmcnt(8)
  v_mfma_f32_16x16x32_bf16 v[60:63], v[80:83], v[20:23], v[60:63]
  ds_read_b64_tr_b16 v[80:81], v6 offset:10336
  ds_read_b64_tr_b16 v[82:83], v6 offset:10976
  s_waitcnt lgkmcnt(8)
  v_mfma_f32_16x16x32_bf16 v[64:67], v[84:87], v[20:23], v[64:67]
  s_waitcnt vmcnt(5)
  ds_read_b64_tr_b16 v[84:85], v6 offset:10368
  ds_read_b64_tr_b16 v[86:87], v6 offset:11008
  s_waitcnt lgkmcnt(8)
  v_mfma_f32_16x16x32_bf16 v[48:51], v[68:71], v[24:27], v[48:51]
  ds_read_b64_tr_b16 v[68:69], v6 offset:15360
  ds_read_b64_tr_b16 v[70:71], v6 offset:16000
  s_waitcnt lgkmcnt(8)
  v_mfma_f32_16x16x32_bf16 v[52:55], v[72:75], v[24:27], v[52:55]
  ds_read_b64_tr_b16 v[72:73], v6 offset:15392
  ds_read_b64_tr_b16 v[74:75], v6 offset:16032
  s_waitcnt lgkmcnt(8)
  v_mfma_f32_16x16x32_bf16 v[56:59], v[76:79], v[24:27], v[56:59]
  ds_read_b64_tr_b16 v[76:77], v6 offset:15424
  ds_read_b64_tr_b16 v[78:79], v6 offset:16064
  s_waitcnt lgkmcnt(8)
  v_mfma_f32_16x16x32_bf16 v[60:63], v[80:83], v[24:27], v[60:63]
  ds_read_b64_tr_b16 v[80:81], v6 offset:15456
  ds_read_b64_tr_b16 v[82:83], v6 offset:16096
  s_waitcnt lgkmcnt(8)
  v_mfma_f32_16x16x32_bf16 v[64:67], v[84:87], v[24:27], v[64:67]
  s_waitcnt vmcnt(4)
  ds_read_b64_tr_b16 v[84:85], v6 offset:15488
  ds_read_b64_tr_b16 v[86:87], v6 offset:16128
  s_waitcnt lgkmcnt(8)
  v_mfma_f32_16x16x32_bf16 v[48:51], v[68:71], v[28:31], v[48:51]
  ds_read_b64_tr_b16 v[68:69], v6 offset:20480
  ds_read_b64_tr_b16 v[70:71], v6 offset:21120
  s_waitcnt lgkmcnt(8)
  v_mfma_f32_16x16x32_bf16 v[52:55], v[72:75], v[28:31], v[52:55]
  ds_read_b64_tr_b16 v[72:73], v6 offset:20512
  ds_read_b64_tr_b16 v[74:75], v6 offset:21152
  s_waitcnt lgkmcnt(8)
  v_mfma_f32_16x16x32_bf16 v[56:59], v[76:79], v[28:31], v[56:59]
  ds_read_b64_tr_b16 v[76:77], v6 offset:20544
  ds_read_b64_tr_b16 v[78:79], v6 offset:21184
  s_waitcnt lgkmcnt(8)
  v_mfma_f32_16x16x32_bf16 v[60:63], v[80:83], v[28:31], v[60:63]
  ds_read_b64_tr_b16 v[80:81], v6 offset:20576
  ds_read_b64_tr_b16 v[82:83], v6 offset:21216
  s_waitcnt lgkmcnt(8)
  v_mfma_f32_16x16x32_bf16 v[64:67], v[84:87], v[28:31], v[64:67]
  s_waitcnt vmcnt(3)
  ds_read_b64_tr_b16 v[84:85], v6 offset:20608
  ds_read_b64_tr_b16 v[86:87], v6 offset:21248
  s_waitcnt lgkmcnt(8)
  v_mfma_f32_16x16x32_bf16 v[48:51], v[68:71], v[32:35], v[48:51]
  ds_read_b64_tr_b16 v[68:69], v6 offset:25600
  ds_read_b64_tr_b16 v[70:71], v6 offset:26240
  s_waitcnt lgkmcnt(8)
  v_mfma_f32_16x16x32_bf16 v[52:55], v[72:75], v[32:35], v[52:55]
  ds_read_b64_tr_b16 v[72:73], v6 offset:25632
  ds_read_b64_tr_b16 v[74:75], v6 offset:26272
  s_waitcnt lgkmcnt(8)
  v_mfma_f32_16x16x32_bf16 v[56:59], v[76:79], v[32:35], v[56:59]
  ds_read_b64_tr_b16 v[76:77], v6 offset:25664
  ds_read_b64_tr_b16 v[78:79], v6 offset:26304
  s_waitcnt lgkmcnt(8)
  v_mfma_f32_16x16x32_bf16 v[60:63], v[80:83], v[32:35], v[60:63]
  ds_read_b64_tr_b16 v[80:81], v6 offset:25696
  ds_read_b64_tr_b16 v[82:83], v6 offset:26336
  s_waitcnt lgkmcnt(8)
  v_mfma_f32_16x16x32_bf16 v[64:67], v[84:87], v[32:35], v[64:67]
  s_waitcnt vmcnt(2)
  ds_read_b64_tr_b16 v[84:85], v6 offset:25728
  ds_read_b64_tr_b16 v[86:87], v6 offset:26368
  s_waitcnt lgkmcnt(8)
  v_mfma_f32_16x16x32_bf16 v[48:51], v[68:71], v[36:39], v[48:51]
  ds_read_b64_tr_b16 v[68:69], v6 offset:30720
  ds_read_b64_tr_b16 v[70:71], v6 offset:31360
  s_waitcnt lgkmcnt(8)
  v_mfma_f32_16x16x32_bf16 v[52:55], v[72:75], v[36:39], v[52:55]
  ds_read_b64_tr_b16 v[72:73], v6 offset:30752
  ds_read_b64_tr_b16 v[74:75], v6 offset:31392
  s_waitcnt lgkmcnt(8)
  v_mfma_f32_16x16x32_bf16 v[56:59], v[76:79], v[36:39], v[56:59]
  ds_read_b64_tr_b16 v[76:77], v6 offset:30784
  ds_read_b64_tr_b16 v[78:79], v6 offset:31424
  s_waitcnt lgkmcnt(8)
  v_mfma_f32_16x16x32_bf16 v[60:63], v[80:83], v[36:39], v[60:63]
  ds_read_b64_tr_b16 v[80:81], v6 offset:30816
  ds_read_b64_tr_b16 v[82:83], v6 offset:31456
  s_waitcnt lgkmcnt(8)
  v_mfma_f32_16x16x32_bf16 v[64:67], v[84:87], v[36:39], v[64:67]
  s_waitcnt vmcnt(1)
  ds_read_b64_tr_b16 v[84:85], v6 offset:30848
  ds_read_b64_tr_b16 v[86:87], v6 offset:31488
  s_waitcnt lgkmcnt(8)
  v_mfma_f32_16x16x32_bf16 v[48:51], v[68:71], v[40:43], v[48:51]
  ds_read_b64_tr_b16 v[68:69], v6 offset:35840
  ds_read_b64_tr_b16 v[70:71], v6 offset:36480
  s_waitcnt lgkmcnt(8)
  v_mfma_f32_16x16x32_bf16 v[52:55], v[72:75], v[40:43], v[52:55]
  ds_read_b64_tr_b16 v[72:73], v6 offset:35872
  ds_read_b64_tr_b16 v[74:75], v6 offset:36512
  s_waitcnt lgkmcnt(8)
  v_mfma_f32_16x16x32_bf16 v[56:59], v[76:79], v[40:43], v[56:59]
  ds_read_b64_tr_b16 v[76:77], v6 offset:35904
  ds_read_b64_tr_b16 v[78:79], v6 offset:36544
  s_waitcnt lgkmcnt(8)
  v_mfma_f32_16x16x32_bf16 v[60:63], v[80:83], v[40:43], v[60:63]
  ds_read_b64_tr_b16 v[80:81], v6 offset:35936
  ds_read_b64_tr_b16 v[82:83], v6 offset:36576
  s_waitcnt lgkmcnt(8)
  v_mfma_f32_16x16x32_bf16 v[64:67], v[84:87], v[40:43], v[64:67]
  s_waitcnt vmcnt(0)
  ds_read_b64_tr_b16 v[84:85], v6 offset:35968
  ds_read_b64_tr_b16 v[86:87], v6 offset:36608
  s_waitcnt lgkmcnt(8)
  v_mfma_f32_16x16x32_bf16 v[48:51], v[68:71], v[44:47], v[48:51]
  s_waitcnt lgkmcnt(6)
  v_mfma_f32_16x16x32_bf16 v[52:55], v[72:75], v[44:47], v[52:55]
  s_waitcnt lgkmcnt(4)
  v_mfma_f32_16x16x32_bf16 v[56:59], v[76:79], v[44:47], v[56:59]
  s_waitcnt lgkmcnt(2)
  v_mfma_f32_16x16x32_bf16 v[60:63], v[80:83], v[44:47], v[60:63]
  s_waitcnt lgkmcnt(0)
  v_mfma_f32_16x16x32_bf16 v[64:67], v[84:87], v[44:47], v[64:67]
  s_nop 7
  s_barrier
  s_cmp_lg_u32 s88, 0
  s_cbranch_scc1 L_op_k1_93
  ds_write_b128 v2, v[60:63] offset:0
  ds_write_b128 v2, v[64:67] offset:1024
  s_branch L_op_x_94
L_op_k1_93:
  ds_write_b128 v2, v[48:51] offset:0
  ds_write_b128 v2, v[52:55] offset:1024
  ds_write_b128 v2, v[56:59] offset:2048
L_op_x_94:
  s_waitcnt lgkmcnt(0)
  s_barrier
  s_cmp_lg_u32 s88, 0
  s_cbranch_scc1 L_op_k1b_95
  ds_read_b128 v[8:11], v4 offset:0
  ds_read_b128 v[12:15], v4 offset:1024
  ds_read_b128 v[16:19], v4 offset:2048
  s_waitcnt lgkmcnt(2)
  v_add_f32 v48, v48, v8
  v_add_f32 v49, v49, v9
  v_add_f32 v50, v50, v10
  v_add_f32 v51, v51, v11
  v_cvt_pk_bf16_f32 v24, v48, v49
  v_cvt_pk_bf16_f32 v25, v50, v51
  buffer_store_dwordx2 v[24:25], v3, s[52:55], s57 offen offset:0
  s_waitcnt lgkmcnt(1)
  v_add_f32 v52, v52, v12
  v_add_f32 v53, v53, v13
  v_add_f32 v54, v54, v14
  v_add_f32 v55, v55, v15
  v_cvt_pk_bf16_f32 v26, v52, v53
  v_cvt_pk_bf16_f32 v27, v54, v55
  buffer_store_dwordx2 v[26:27], v3, s[52:55], s57 offen offset:32
  s_waitcnt lgkmcnt(0)
  v_add_f32 v56, v56, v16
  v_add_f32 v57, v57, v17
  v_add_f32 v58, v58, v18
  v_add_f32 v59, v59, v19
  v_cvt_pk_bf16_f32 v28, v56, v57
  v_cvt_pk_bf16_f32 v29, v58, v59
  buffer_store_dwordx2 v[28:29], v3, s[52:55], s57 offen offset:64
  s_branch L_op_end_96
L_op_k1b_95:
  ds_read_b128 v[8:11], v4 offset:0
  ds_read_b128 v[12:15], v4 offset:1024
  s_waitcnt lgkmcnt(1)
  v_add_f32 v60, v60, v8
  v_add_f32 v61, v61, v9
  v_add_f32 v62, v62, v10
  v_add_f32 v63, v63, v11
  v_cvt_pk_bf16_f32 v24, v60, v61
  v_cvt_pk_bf16_f32 v25, v62, v63
  buffer_store_dwordx2 v[24:25], v3, s[52:55], s57 offen offset:96
  s_waitcnt lgkmcnt(0)
  v_add_f32 v64, v64, v12
  v_add_f32 v65, v65, v13
  v_add_f32 v66, v66, v14
  v_add_f32 v67, v67, v15
  v_cvt_pk_bf16_f32 v26, v64, v65
  v_cvt_pk_bf16_f32 v27, v66, v67
  buffer_store_dwordx2 v[26:27], v3, s[52:55], s57 offen offset:128
L_op_end_96:
  s_endpgm
L_code_end:
.section .rodata,"a"
.p2align 6
.amdhsa_kernel concat_heads__ssm_conv_s4__grouped_kv_mqa__prompt_kernel
  .amdhsa_next_free_vgpr 128
  .amdhsa_next_free_sgpr 102
  .amdhsa_accum_offset 128
  .amdhsa_group_segment_fixed_size 0
  .amdhsa_kernarg_size 136
  .amdhsa_user_sgpr_count 2
  .amdhsa_user_sgpr_kernarg_segment_ptr 1
  .amdhsa_system_sgpr_workgroup_id_x 1
.end_amdhsa_kernel
```
